```python
import torch

def _softmax(x, axis=-1):
    return torch.softmax(x, dim=axis)
def _gelu(x):
    return torch.nn.functional.gelu(x, approximate="tanh")
def _silu(x):
    return torch.nn.functional.silu(x)
def _sigmoid(x):
    return torch.sigmoid(x)
def _layernorm(x, axis=-1, eps=1e-5):
    m = x.mean(dim=axis, keepdim=True)
    v = x.var(dim=axis, keepdim=True, unbiased=False)
    return (x - m) / torch.sqrt(v + eps)
def _scatter_add(tgt, idx, src, axis=0):
    return tgt.clone().index_add_(axis, idx, src)
def _segment_sum(src, seg, n):
    out = torch.zeros((n,) + src.shape[1:], dtype=src.dtype)
    return out.index_add_(0, seg, src)
def _pad(x, pw):
    flat = tuple(v for pair in reversed(pw) for v in pair)
    return torch.nn.functional.pad(x, flat)

kernel_name = 'gated_mix__sliding_local_dilated__dense_activation_gelu__prompt'

def setup_inputs():

    _w = (lambda a: (lambda t: t.to(torch.bfloat16) if t.is_floating_point() else t)(torch.as_tensor(a)))
    def _A_setup():
        B, S, D = 1, 2048, 512
        return {
            "x": _w((lambda *s: torch.randn(*s, dtype=torch.bfloat16) * 0.05)(B, S, D)),
            "wqkv": _w((lambda *s: torch.randn(*s, dtype=torch.bfloat16) * 0.8)(D, 3 * D)),
            "wo": _w((lambda *s: torch.randn(*s, dtype=torch.bfloat16) * 0.05)(D, D)),
        }
    _A_in = _A_setup()

    def _B_setup():
        B, S, D, F = 1, 2048, 512, 1792
        return {
            "x": _w((lambda *s: torch.randn(*s, dtype=torch.bfloat16) * 0.05)(B, S, D)),
            "w1": _w((lambda *s: torch.randn(*s, dtype=torch.bfloat16) * 12.8)(D, F) * (D ** -0.5)),
            "b1": _w((lambda *s: torch.randn(*s, dtype=torch.bfloat16) * 12.8)(F) * 0.01),
            "w2": _w((lambda *s: torch.randn(*s, dtype=torch.bfloat16) * 1.6)(F, D) * (F ** -0.5)),
            "b2": _w((lambda *s: torch.randn(*s, dtype=torch.bfloat16) * 12.8)(D) * 0.01),
        }
    _B_in = _B_setup()

    return {
        "A_x": _A_in["x"],
        "A_wqkv": _A_in["wqkv"],
        "A_wo": _A_in["wo"],
        "B_x": _B_in["x"],
        "B_w1": _B_in["w1"],
        "B_b1": _B_in["b1"],
        "B_w2": _B_in["w2"],
        "B_b2": _B_in["b2"],
        "gate_w": _w((lambda *s: torch.randn(*s, dtype=torch.bfloat16) * 0.05)(512) * 16.0),
    }

def reference(A_x, A_wqkv, A_wo, B_x, B_w1, B_b1, B_w2, B_b2, gate_w):
    def _A_ref(x, wqkv, wo):
        B, S, D = x.shape
        H = 32; Dh = D // H
        W, dil = 8, 2
        qkv = (lambda x, *d: x.permute(*d))((x @ wqkv).reshape(B, S, 3, H, Dh), 2, 0, 3, 1, 4)
        q, k, v = qkv[0], qkv[1], qkv[2]
        scale = Dh ** -0.5
        pos = torch.arange(S)
        off = torch.arange(W) * dil
        idx = pos[:, None] - off[None, :]
        mask = idx >= 0
        idx_c = torch.where(mask, idx, 0).reshape(-1)
        kg = k[:, :, idx_c, :].reshape(B, H, S, W, Dh)
        vg = v[:, :, idx_c, :].reshape(B, H, S, W, Dh)
        logits = torch.einsum("bhsd,bhswd->bhsw", q, kg) * scale
        logits = torch.where(mask[None, None, :, :], logits, -1e9)
        attn = _softmax(logits, axis=-1)
        o = torch.einsum("bhsw,bhswd->bhsd", attn, vg)
        return (lambda x, *d: x.permute(*d))(o, 0, 2, 1, 3).reshape(B, S, D) @ wo

    def _B_ref(x, w1, b1, w2, b2):
        h = torch.einsum("bsd,df->bsf", x, w1) + b1
        h = _gelu(h)
        return torch.einsum("bsf,fd->bsd", h, w2) + b2

    x = A_x
    g = _sigmoid((x * gate_w).sum(-1, keepdims=True))
    a = _A_ref(x, A_wqkv, A_wo)
    b = _B_ref(x, B_w1, B_b1, B_w2, B_b2)
    return g * a + (1 - g) * b
```

```asm
; @launch grid=(256,1,1) block=(512,1,1) lds=163840
.amdgcn_target "amdgcn-amd-amdhsa--gfx950"
.text
.globl gated_mix__sliding_local_dilated__dense_activation_gelu__prompt_kernel
.p2align 8
.type gated_mix__sliding_local_dilated__dense_activation_gelu__prompt_kernel,@function
gated_mix__sliding_local_dilated__dense_activation_gelu__prompt_kernel:
    s_cmp_ge_u32 s2, 0x100
    s_cbranch_scc1 L_END
    s_load_dwordx16 s[4:19], s[0:1], 0
    s_load_dwordx8 s[20:27], s[0:1], 64
    v_lshrrev_b32 v1, 6, v0
    v_and_b32 v144, 63, v0
    s_and_b32 s68, s2, 7
    v_readfirstlane_b32 s60, v1
    s_lshr_b32 s69, s2, 3
    s_and_b32 s70, s69, 7
    s_lshr_b32 s71, s69, 3
    s_and_b32 s61, s68, 1
    s_lshl_b32 s61, s61, 3
    s_add_u32 s61, s61, s70
    s_and_b32 s62, s68, 6
    s_lshr_b32 s72, s71, 1
    s_add_u32 s62, s62, s72
    s_and_b32 s63, s71, 1
    s_lshl_b32 s64, s71, 1
    s_add_u32 s64, s64, s70
    s_lshl_b32 s64, s64, 0
    s_and_b32 s64, s64, 7
    s_and_b32 s67, s60, 3
    s_lshl_b32 s65, s68, 2
    s_and_b32 s72, s69, 3
    s_add_u32 s65, s65, s72
    s_lshr_b32 s66, s69, 2
    s_waitcnt lgkmcnt(0)
    s_mov_b32 s28, s4
    s_mov_b32 s29, s5
    s_mov_b32 s30, 2097152
    s_mov_b32 s31, 0x00020000
    s_cmp_ge_u32 s60, 4
    s_cbranch_scc1 L_COMPUTE
    v_lshrrev_b32 v16, 3, v144
    v_lshrrev_b32 v17, 4, v144
    v_and_b32 v18, 7, v144
    v_xor_b32 v19, v18, v17
    s_lshl_b32 s68, s61, 7
    s_lshl_b32 s69, s67, 5
    s_add_u32 s69, s69, s68
    v_lshl_add_u32 v2, v16, 1, s69
    v_lshlrev_b32 v2, 10, v2
    v_lshl_add_u32 v2, v19, 4, v2
    v_xor_b32 v4, 64, v2
    v_add_u32 v5, 17408, v2
    v_add_u32 v3, 16384, v4
    v_add_u32 v4, 1024, v4
    s_cmp_eq_u32 s63, 1
    s_cbranch_scc1 L_LSET_ATT
    s_mov_b32 s32, s12
    s_mov_b32 s33, s13
    s_mov_b32 s34, 1835008
    s_mov_b32 s35, 0x00020000
    s_mov_b32 s56, s12
    s_mov_b32 s57, s13
    s_mov_b32 s58, 1835008
    s_mov_b32 s59, 0x00020000
    s_mov_b32 s78, 229376
    s_mov_b32 s79, 229376
    s_mov_b64 s[80:81], -1
    s_mul_i32 s77, s67, 7168
    s_add_u32 s77, s77, 16384
    s_add_u32 s76, s77, 1024
    s_mul_i32 s68, s67, 57344
    s_mul_i32 s69, s62, 448
    s_add_u32 s68, s68, s69
    s_movk_i32 s69, 2341
    s_movk_i32 s70, 3584
    v_add_u32 v20, 0, v144
    v_mul_u32_u24 v21, s69, v20
    v_lshrrev_b32 v21, 16, v21
    v_mul_u32_u24 v22, 28, v21
    v_sub_u32 v22, v20, v22
    v_lshrrev_b32 v23, 3, v21
    v_lshlrev_b32 v23, 1, v23
    v_xor_b32 v22, v22, v23
    v_mul_u32_u24 v21, s70, v21
    v_lshl_add_u32 v21, v22, 4, v21
    v_add_u32 v6, s68, v21
    v_add_u32 v20, 64, v144
    v_mul_u32_u24 v21, s69, v20
    v_lshrrev_b32 v21, 16, v21
    v_mul_u32_u24 v22, 28, v21
    v_sub_u32 v22, v20, v22
    v_lshrrev_b32 v23, 3, v21
    v_lshlrev_b32 v23, 1, v23
    v_xor_b32 v22, v22, v23
    v_mul_u32_u24 v21, s70, v21
    v_lshl_add_u32 v21, v22, 4, v21
    v_add_u32 v7, s68, v21
    v_add_u32 v20, 128, v144
    v_mul_u32_u24 v21, s69, v20
    v_lshrrev_b32 v21, 16, v21
    v_mul_u32_u24 v22, 28, v21
    v_sub_u32 v22, v20, v22
    v_lshrrev_b32 v23, 3, v21
    v_lshlrev_b32 v23, 1, v23
    v_xor_b32 v22, v22, v23
    v_mul_u32_u24 v21, s70, v21
    v_lshl_add_u32 v21, v22, 4, v21
    v_add_u32 v8, s68, v21
    v_add_u32 v20, 192, v144
    v_mul_u32_u24 v21, s69, v20
    v_lshrrev_b32 v21, 16, v21
    v_mul_u32_u24 v22, 28, v21
    v_sub_u32 v22, v20, v22
    v_lshrrev_b32 v23, 3, v21
    v_lshlrev_b32 v23, 1, v23
    v_xor_b32 v22, v22, v23
    v_mul_u32_u24 v21, s70, v21
    v_lshl_add_u32 v21, v22, 4, v21
    v_add_u32 v9, s68, v21
    v_add_u32 v20, 256, v144
    v_mul_u32_u24 v21, s69, v20
    v_lshrrev_b32 v21, 16, v21
    v_mul_u32_u24 v22, 28, v21
    v_sub_u32 v22, v20, v22
    v_lshrrev_b32 v23, 3, v21
    v_lshlrev_b32 v23, 1, v23
    v_xor_b32 v22, v22, v23
    v_mul_u32_u24 v21, s70, v21
    v_lshl_add_u32 v21, v22, 4, v21
    v_add_u32 v10, s68, v21
    v_add_u32 v20, 320, v144
    v_mul_u32_u24 v21, s69, v20
    v_lshrrev_b32 v21, 16, v21
    v_mul_u32_u24 v22, 28, v21
    v_sub_u32 v22, v20, v22
    v_lshrrev_b32 v23, 3, v21
    v_lshlrev_b32 v23, 1, v23
    v_xor_b32 v22, v22, v23
    v_mul_u32_u24 v21, s70, v21
    v_lshl_add_u32 v21, v22, 4, v21
    v_add_u32 v11, s68, v21
    v_add_u32 v20, 384, v144
    v_mul_u32_u24 v21, s69, v20
    v_lshrrev_b32 v21, 16, v21
    v_mul_u32_u24 v22, 28, v21
    v_sub_u32 v22, v20, v22
    v_lshrrev_b32 v23, 3, v21
    v_lshlrev_b32 v23, 1, v23
    v_xor_b32 v22, v22, v23
    v_mul_u32_u24 v21, s70, v21
    v_lshl_add_u32 v21, v22, 4, v21
    v_add_u32 v12, s68, v21
    s_branch L_LSET_DONE
L_LSET_ATT:
    s_mov_b32 s32, s6
    s_mov_b32 s33, s7
    s_mov_b32 s34, 1572864
    s_mov_b32 s35, 0x00020000
    s_mov_b32 s56, s4
    s_mov_b32 s57, s5
    s_mov_b32 s58, 2097152
    s_mov_b32 s59, 0x00020000
    s_mov_b32 s78, 196608
    s_movk_i32 s79, 128
    s_mov_b32 s80, -1
    s_mov_b32 s81, 0
    s_lshl_b32 s77, s67, 9
    s_add_u32 s77, s77, 16384
    s_mul_i32 s76, s67, 6144
    s_add_u32 s76, s76, 18432
    s_lshl_b32 s69, s67, 2
    v_add_u32 v20, s69, v16
    v_and_b32 v21, 7, v20
    v_lshlrev_b32 v21, 1, v21
    v_bfe_u32 v22, v20, 3, 1
    s_sub_u32 s68, s68, 16
    v_add3_u32 v21, v21, v22, s68
    v_max_i32 v21, 0, v21
    v_bfe_u32 v22, v20, 1, 3
    v_xor_b32 v22, v22, v18
    v_lshlrev_b32 v21, 10, v21
    v_lshl_add_u32 v6, v22, 4, v21
    s_mul_i32 s68, s67, 49152
    s_lshl_b32 s69, s62, 7
    s_add_u32 s68, s68, s69
    s_movk_i32 s70, 3072
    v_mul_u32_u24 v20, s70, v16
    v_and_b32 v21, 1, v17
    v_lshlrev_b32 v21, 1, v21
    v_xor_b32 v21, v21, v18
    v_lshl_add_u32 v20, v21, 4, v20
    v_add_u32 v7, s68, v20
    v_xor_b32 v20, 64, v20
    v_add_u32 v20, 24576, v20
    v_add_u32 v8, s68, v20
    v_add_u32 v9, 1024, v7
    v_add_u32 v10, 1024, v8
    v_add_u32 v11, 2048, v7
    v_add_u32 v12, 2048, v8
L_LSET_DONE:
    s_mov_b32 s74, 73728
    s_lshl_b32 s68, s64, 7
    s_mul_i32 s69, s64, s79
    s_mul_i32 s70, s64, s78
    s_lshl_b32 s71, s67, 12
    s_add_u32 m0, s74, s71
    s_add_u32 s64, s64, 1
    buffer_load_dwordx4 v2, s[28:31], s68 offen lds
    s_add_u32 m0, m0, 0x400
    s_nop 0
    buffer_load_dwordx4 v3, s[28:31], s68 offen lds
    s_add_u32 m0, m0, 0x400
    s_nop 0
    buffer_load_dwordx4 v4, s[28:31], s68 offen lds
    s_add_u32 m0, m0, 0x400
    s_nop 0
    buffer_load_dwordx4 v5, s[28:31], s68 offen lds
    s_add_u32 m0, s74, s77
    s_mov_b64 exec, s[80:81]
    buffer_load_dwordx4 v6, s[56:59], s69 offen lds
    s_add_u32 m0, s74, s76
    s_mov_b64 exec, -1
    buffer_load_dwordx4 v7, s[32:35], s70 offen lds
    s_add_u32 m0, m0, 0x400
    s_nop 0
    buffer_load_dwordx4 v8, s[32:35], s70 offen lds
    s_add_u32 m0, m0, 0x400
    s_nop 0
    buffer_load_dwordx4 v9, s[32:35], s70 offen lds
    s_add_u32 m0, m0, 0x400
    s_nop 0
    buffer_load_dwordx4 v10, s[32:35], s70 offen lds
    s_add_u32 m0, m0, 0x400
    s_nop 0
    buffer_load_dwordx4 v11, s[32:35], s70 offen lds
    s_add_u32 m0, m0, 0x400
    s_nop 0
    buffer_load_dwordx4 v12, s[32:35], s70 offen lds
    s_and_b32 s64, s64, 7
    s_add_u32 s74, s74, 45056
    s_cmp_gt_u32 s74, 118784
    s_cselect_b32 s74, 28672, s74
    s_lshl_b32 s68, s64, 7
    s_mul_i32 s69, s64, s79
    s_mul_i32 s70, s64, s78
    s_lshl_b32 s71, s67, 12
    s_add_u32 m0, s74, s71
    s_add_u32 s64, s64, 1
    buffer_load_dwordx4 v2, s[28:31], s68 offen lds
    s_add_u32 m0, m0, 0x400
    s_nop 0
    buffer_load_dwordx4 v3, s[28:31], s68 offen lds
    s_add_u32 m0, m0, 0x400
    s_nop 0
    buffer_load_dwordx4 v4, s[28:31], s68 offen lds
    s_add_u32 m0, m0, 0x400
    s_nop 0
    buffer_load_dwordx4 v5, s[28:31], s68 offen lds
    s_add_u32 m0, s74, s77
    s_mov_b64 exec, s[80:81]
    buffer_load_dwordx4 v6, s[56:59], s69 offen lds
    s_add_u32 m0, s74, s76
    s_mov_b64 exec, -1
    buffer_load_dwordx4 v7, s[32:35], s70 offen lds
    s_add_u32 m0, m0, 0x400
    s_nop 0
    buffer_load_dwordx4 v8, s[32:35], s70 offen lds
    s_add_u32 m0, m0, 0x400
    s_nop 0
    buffer_load_dwordx4 v9, s[32:35], s70 offen lds
    s_add_u32 m0, m0, 0x400
    s_nop 0
    buffer_load_dwordx4 v10, s[32:35], s70 offen lds
    s_add_u32 m0, m0, 0x400
    s_nop 0
    buffer_load_dwordx4 v11, s[32:35], s70 offen lds
    s_add_u32 m0, m0, 0x400
    s_nop 0
    buffer_load_dwordx4 v12, s[32:35], s70 offen lds
    s_and_b32 s64, s64, 7
    s_add_u32 s74, s74, 45056
    s_cmp_gt_u32 s74, 118784
    s_cselect_b32 s74, 28672, s74
    v_and_b32 v13, 31, v144
    v_lshlrev_b32 v13, 2, v13
    s_lshl_b32 s68, s67, 7
    v_add_u32 v13, s68, v13
    v_bfe_u32 v24, v144, 3, 2
    v_lshlrev_b32 v24, 7, v24
    v_lshl_add_u32 v24, v18, 3, v24
    s_lshl_b32 s68, s61, 11
    s_lshl_b32 s69, s67, 9
    s_add_u32 s68, s68, 9437184
    s_add_u32 s82, s68, s69
    s_lshl_b32 s69, s63, 3
    s_add_u32 s69, s69, s62
    s_lshl_b32 s69, s69, 7
    s_add_u32 s83, s68, s69
    v_lshlrev_b32 v19, 1, v17
    v_xor_b32 v19, v19, v18
    v_lshlrev_b32 v16, 10, v16
    v_lshl_add_u32 v16, v19, 4, v16
    s_lshl_b32 s68, s66, 7
    v_add_u32 v16, s68, v16
    v_add_u32 v17, 8192, v16
    v_add_u32 v18, 16384, v16
    v_add_u32 v19, 24576, v16
    s_mov_b32 s36, s16
    s_mov_b32 s37, s17
    s_mov_b32 s38, 1835008
    s_mov_b32 s39, 0x00020000
    s_mov_b32 s40, s8
    s_mov_b32 s41, s9
    s_mov_b32 s42, 524288
    s_mov_b32 s43, 0x00020000
    s_xor_b32 s68, s65, s66
    s_and_b32 s68, s68, 1
    s_lshl_b32 s68, s68, 2
    s_xor_b32 s10, s60, s68
    s_bfe_u32 s3, s65, 0x10001
    s_mul_i32 s68, s3, 0
    s_mul_i32 s75, s66, 1
    s_add_u32 s75, s75, s68
    s_lshr_b32 s68, s65, 2
    s_mul_i32 s68, s68, 3
    s_add_u32 s75, s75, s68
    s_mul_i32 s68, s75, 37
    s_lshr_b32 s68, s68, 8
    s_mul_i32 s68, s68, 7
    s_sub_u32 s75, s75, s68
    s_mov_b32 s44, s26
    s_mov_b32 s45, s27
    s_mov_b32 s46, 0x920000
    s_mov_b32 s47, 0x00020000
    s_mov_b32 s52, s24
    s_mov_b32 s53, s25
    s_mov_b32 s54, 256
    s_mov_b32 s55, 0x00020000
    s_mov_b32 s48, s22
    s_mov_b32 s49, s23
    s_mov_b32 s50, 2097152
    s_mov_b32 s51, 0x00020000
    s_mov_b32 s68, 9486336
    s_load_dword s85, s[26:27], s68
    s_lshl_b32 s68, s2, 3
    s_add_u32 s68, s68, s60
    s_cmp_eq_u32 s68, 1
    s_cselect_b32 s84, 1, 0
    v_lshrrev_b32 v150, 2, v144
    v_and_b32 v151, 3, v144
    v_lshlrev_b32 v145, 7, v150
    v_lshl_add_u32 v145, v151, 3, v145
    v_bfe_u32 v150, v150, 1, 2
    v_lshl_add_u32 v145, v150, 5, v145
    s_lshl_b32 s68, s67, 12
    s_add_u32 s68, s68, 4096
    v_add_u32 v145, s68, v145
    v_xor_b32 v146, 32, v145
    v_xor_b32 v147, 64, v145
    v_xor_b32 v148, 0x60, v145
    s_mov_b32 s48, s18
    s_mov_b32 s49, s19
    s_mov_b32 s50, 1024
    s_mov_b32 s51, 0x00020000
    s_lshl_b32 s68, s66, 7
    buffer_load_dword v25, off, s[48:51], s68
    s_mov_b32 s48, s22
    s_mov_b32 s49, s23
    s_mov_b32 s50, 2097152
    s_mov_b32 s51, 0x00020000
    s_waitcnt vmcnt(12) lgkmcnt(0)
    s_barrier
    buffer_load_dword v14, off, s[52:55], 0 sc1
    s_lshl_b32 s68, s64, 7
    s_mul_i32 s69, s64, s79
    s_mul_i32 s70, s64, s78
    s_lshl_b32 s71, s67, 12
    s_add_u32 m0, s74, s71
    s_add_u32 s64, s64, 1
    buffer_load_dwordx4 v2, s[28:31], s68 offen lds
    s_add_u32 m0, m0, 0x400
    s_nop 0
    buffer_load_dwordx4 v3, s[28:31], s68 offen lds
    s_add_u32 m0, m0, 0x400
    s_nop 0
    buffer_load_dwordx4 v4, s[28:31], s68 offen lds
    s_add_u32 m0, m0, 0x400
    s_nop 0
    buffer_load_dwordx4 v5, s[28:31], s68 offen lds
    s_add_u32 m0, s74, s77
    s_mov_b64 exec, s[80:81]
    buffer_load_dwordx4 v6, s[56:59], s69 offen lds
    s_add_u32 m0, s74, s76
    s_mov_b64 exec, -1
    buffer_load_dwordx4 v7, s[32:35], s70 offen lds
    s_add_u32 m0, m0, 0x400
    s_nop 0
    buffer_load_dwordx4 v8, s[32:35], s70 offen lds
    s_add_u32 m0, m0, 0x400
    s_nop 0
    buffer_load_dwordx4 v9, s[32:35], s70 offen lds
    s_add_u32 m0, m0, 0x400
    s_nop 0
    buffer_load_dwordx4 v10, s[32:35], s70 offen lds
    s_add_u32 m0, m0, 0x400
    s_nop 0
    buffer_load_dwordx4 v11, s[32:35], s70 offen lds
    s_add_u32 m0, m0, 0x400
    s_nop 0
    buffer_load_dwordx4 v12, s[32:35], s70 offen lds
    s_and_b32 s64, s64, 7
    s_add_u32 s74, s74, 45056
    s_cmp_gt_u32 s74, 118784
    s_cselect_b32 s74, 28672, s74
    s_waitcnt vmcnt(11)
    s_barrier
    v_readfirstlane_b32 s69, v14
    s_add_u32 s11, s85, 0x9e3779b9
    s_max_u32 s11, s11, 1
    s_cmp_lg_u32 s69, 0
    s_cselect_b32 s11, s69, s11
    v_lshlrev_b32 v20, 2, v144
    ds_read_b32 v22, v20 offset:0
    v_mov_b32 v23, s11
    s_lshl_b32 s68, s64, 7
    s_mul_i32 s69, s64, s79
    s_mul_i32 s70, s64, s78
    s_lshl_b32 s71, s67, 12
    s_add_u32 m0, s74, s71
    s_add_u32 s64, s64, 1
    buffer_load_dwordx4 v2, s[28:31], s68 offen lds
    s_add_u32 m0, m0, 0x400
    s_nop 0
    buffer_load_dwordx4 v3, s[28:31], s68 offen lds
    s_add_u32 m0, m0, 0x400
    s_nop 0
    buffer_load_dwordx4 v4, s[28:31], s68 offen lds
    s_add_u32 m0, m0, 0x400
    s_nop 0
    buffer_load_dwordx4 v5, s[28:31], s68 offen lds
    s_add_u32 m0, s74, s77
    s_mov_b64 exec, s[80:81]
    buffer_load_dwordx4 v6, s[56:59], s69 offen lds
    s_add_u32 m0, s74, s76
    s_mov_b64 exec, -1
    buffer_load_dwordx4 v7, s[32:35], s70 offen lds
    s_add_u32 m0, m0, 0x400
    s_nop 0
    buffer_load_dwordx4 v8, s[32:35], s70 offen lds
    s_add_u32 m0, m0, 0x400
    s_nop 0
    buffer_load_dwordx4 v9, s[32:35], s70 offen lds
    s_add_u32 m0, m0, 0x400
    s_nop 0
    buffer_load_dwordx4 v10, s[32:35], s70 offen lds
    s_add_u32 m0, m0, 0x400
    s_nop 0
    buffer_load_dwordx4 v11, s[32:35], s70 offen lds
    s_add_u32 m0, m0, 0x400
    s_nop 0
    buffer_load_dwordx4 v12, s[32:35], s70 offen lds
    s_and_b32 s64, s64, 7
    s_add_u32 s74, s74, 45056
    s_cmp_gt_u32 s74, 118784
    s_cselect_b32 s74, 28672, s74
    s_cmp_lg_u32 s67, 0
    s_cbranch_scc1 L_NOZST
    v_lshlrev_b32 v21, 3, v144
    s_mov_b64 exec, 0xff
    s_waitcnt lgkmcnt(0)
    buffer_store_dwordx2 v[22:23], v21, s[44:47], s83 offen sc1
    ds_write_b32 v20, v23 offset:64
    s_mov_b64 exec, -1
L_NOZST:
    s_cmp_eq_u32 s84, 1
    s_cbranch_scc1 L_EPUB1
L_EPUBX1:
    s_cmp_le_u32 s67, s84
    s_cbranch_scc1 L_W12_2
    s_waitcnt vmcnt(11)
L_W12_2:
    s_waitcnt vmcnt(12)
    s_barrier
    s_lshl_b32 s68, s64, 7
    s_mul_i32 s69, s64, s79
    s_mul_i32 s70, s64, s78
    s_lshl_b32 s71, s67, 12
    s_add_u32 m0, s74, s71
    s_add_u32 s64, s64, 1
    buffer_load_dwordx4 v2, s[28:31], s68 offen lds
    s_add_u32 m0, m0, 0x400
    s_nop 0
    buffer_load_dwordx4 v3, s[28:31], s68 offen lds
    s_add_u32 m0, m0, 0x400
    s_nop 0
    buffer_load_dwordx4 v4, s[28:31], s68 offen lds
    s_add_u32 m0, m0, 0x400
    s_nop 0
    buffer_load_dwordx4 v5, s[28:31], s68 offen lds
    s_add_u32 m0, s74, s77
    s_mov_b64 exec, s[80:81]
    buffer_load_dwordx4 v6, s[56:59], s69 offen lds
    s_add_u32 m0, s74, s76
    s_mov_b64 exec, -1
    buffer_load_dwordx4 v7, s[32:35], s70 offen lds
    s_add_u32 m0, m0, 0x400
    s_nop 0
    buffer_load_dwordx4 v8, s[32:35], s70 offen lds
    s_add_u32 m0, m0, 0x400
    s_nop 0
    buffer_load_dwordx4 v9, s[32:35], s70 offen lds
    s_add_u32 m0, m0, 0x400
    s_nop 0
    buffer_load_dwordx4 v10, s[32:35], s70 offen lds
    s_add_u32 m0, m0, 0x400
    s_nop 0
    buffer_load_dwordx4 v11, s[32:35], s70 offen lds
    s_add_u32 m0, m0, 0x400
    s_nop 0
    buffer_load_dwordx4 v12, s[32:35], s70 offen lds
    s_and_b32 s64, s64, 7
    s_add_u32 s74, s74, 45056
    s_cmp_gt_u32 s74, 118784
    s_cselect_b32 s74, 28672, s74
    s_waitcnt vmcnt(11)
    s_barrier
    s_lshl_b32 s68, s64, 7
    s_mul_i32 s69, s64, s79
    s_mul_i32 s70, s64, s78
    s_lshl_b32 s71, s67, 12
    s_add_u32 m0, s74, s71
    s_add_u32 s64, s64, 1
    buffer_load_dwordx4 v2, s[28:31], s68 offen lds
    s_add_u32 m0, m0, 0x400
    s_nop 0
    buffer_load_dwordx4 v3, s[28:31], s68 offen lds
    s_add_u32 m0, m0, 0x400
    s_nop 0
    buffer_load_dwordx4 v4, s[28:31], s68 offen lds
    s_add_u32 m0, m0, 0x400
    s_nop 0
    buffer_load_dwordx4 v5, s[28:31], s68 offen lds
    s_add_u32 m0, s74, s77
    s_mov_b64 exec, s[80:81]
    buffer_load_dwordx4 v6, s[56:59], s69 offen lds
    s_add_u32 m0, s74, s76
    s_mov_b64 exec, -1
    buffer_load_dwordx4 v7, s[32:35], s70 offen lds
    s_add_u32 m0, m0, 0x400
    s_nop 0
    buffer_load_dwordx4 v8, s[32:35], s70 offen lds
    s_add_u32 m0, m0, 0x400
    s_nop 0
    buffer_load_dwordx4 v9, s[32:35], s70 offen lds
    s_add_u32 m0, m0, 0x400
    s_nop 0
    buffer_load_dwordx4 v10, s[32:35], s70 offen lds
    s_add_u32 m0, m0, 0x400
    s_nop 0
    buffer_load_dwordx4 v11, s[32:35], s70 offen lds
    s_add_u32 m0, m0, 0x400
    s_nop 0
    buffer_load_dwordx4 v12, s[32:35], s70 offen lds
    s_and_b32 s64, s64, 7
    s_add_u32 s74, s74, 45056
    s_cmp_gt_u32 s74, 118784
    s_cselect_b32 s74, 28672, s74
    s_cmp_eq_u32 s84, 1
    s_cbranch_scc1 L_EPUB3
L_EPUBX3:
    s_cmp_eq_u32 s84, 1
    s_cbranch_scc1 L_W12_4
    s_waitcnt vmcnt(11)
L_W12_4:
    s_waitcnt vmcnt(12)
    s_barrier
    buffer_load_dwordx2 v[14:15], v24, s[44:47], s82 offen sc1
    s_lshl_b32 s68, s64, 7
    s_mul_i32 s69, s64, s79
    s_mul_i32 s70, s64, s78
    s_lshl_b32 s71, s67, 12
    s_add_u32 m0, s74, s71
    s_add_u32 s64, s64, 1
    buffer_load_dwordx4 v2, s[28:31], s68 offen lds
    s_add_u32 m0, m0, 0x400
    s_nop 0
    buffer_load_dwordx4 v3, s[28:31], s68 offen lds
    s_add_u32 m0, m0, 0x400
    s_nop 0
    buffer_load_dwordx4 v4, s[28:31], s68 offen lds
    s_add_u32 m0, m0, 0x400
    s_nop 0
    buffer_load_dwordx4 v5, s[28:31], s68 offen lds
    s_add_u32 m0, s74, s77
    s_mov_b64 exec, s[80:81]
    buffer_load_dwordx4 v6, s[56:59], s69 offen lds
    s_add_u32 m0, s74, s76
    s_mov_b64 exec, -1
    buffer_load_dwordx4 v7, s[32:35], s70 offen lds
    s_add_u32 m0, m0, 0x400
    s_nop 0
    buffer_load_dwordx4 v8, s[32:35], s70 offen lds
    s_add_u32 m0, m0, 0x400
    s_nop 0
    buffer_load_dwordx4 v9, s[32:35], s70 offen lds
    s_add_u32 m0, m0, 0x400
    s_nop 0
    buffer_load_dwordx4 v10, s[32:35], s70 offen lds
    s_add_u32 m0, m0, 0x400
    s_nop 0
    buffer_load_dwordx4 v11, s[32:35], s70 offen lds
    s_add_u32 m0, m0, 0x400
    s_nop 0
    buffer_load_dwordx4 v12, s[32:35], s70 offen lds
    s_and_b32 s64, s64, 7
    s_add_u32 s74, s74, 45056
    s_cmp_gt_u32 s74, 118784
    s_cselect_b32 s74, 28672, s74
    s_waitcnt vmcnt(11)
    s_barrier
    s_mov_b32 s69, 262144
    v_cmp_ne_u32 vcc, s11, v15
    s_cbranch_vccnz L_ZPOLL
L_ZGOT:
    ds_write_b32 v13, v14 offset:1024
    s_lshl_b32 s68, s64, 7
    s_mul_i32 s69, s64, s79
    s_mul_i32 s70, s64, s78
    s_lshl_b32 s71, s67, 12
    s_add_u32 m0, s74, s71
    s_add_u32 s64, s64, 1
    buffer_load_dwordx4 v2, s[28:31], s68 offen lds
    s_add_u32 m0, m0, 0x400
    s_nop 0
    buffer_load_dwordx4 v3, s[28:31], s68 offen lds
    s_add_u32 m0, m0, 0x400
    s_nop 0
    buffer_load_dwordx4 v4, s[28:31], s68 offen lds
    s_add_u32 m0, m0, 0x400
    s_nop 0
    buffer_load_dwordx4 v5, s[28:31], s68 offen lds
    s_add_u32 m0, s74, s77
    s_mov_b64 exec, s[80:81]
    buffer_load_dwordx4 v6, s[56:59], s69 offen lds
    s_add_u32 m0, s74, s76
    s_mov_b64 exec, -1
    buffer_load_dwordx4 v7, s[32:35], s70 offen lds
    s_add_u32 m0, m0, 0x400
    s_nop 0
    buffer_load_dwordx4 v8, s[32:35], s70 offen lds
    s_add_u32 m0, m0, 0x400
    s_nop 0
    buffer_load_dwordx4 v9, s[32:35], s70 offen lds
    s_add_u32 m0, m0, 0x400
    s_nop 0
    buffer_load_dwordx4 v10, s[32:35], s70 offen lds
    s_add_u32 m0, m0, 0x400
    s_nop 0
    buffer_load_dwordx4 v11, s[32:35], s70 offen lds
    s_add_u32 m0, m0, 0x400
    s_nop 0
    buffer_load_dwordx4 v12, s[32:35], s70 offen lds
    s_and_b32 s64, s64, 7
    s_add_u32 s74, s74, 45056
    s_cmp_gt_u32 s74, 118784
    s_cselect_b32 s74, 28672, s74
    s_xor_b32 s70, s3, 0
    s_xor_b32 s68, s10, 0
    s_lshl_b32 s69, s67, 12
    s_mul_i32 s68, s68, 2
    s_add_u32 m0, s69, 4096
    s_add_u32 s68, s68, s70
    s_lshl_b32 s68, s68, 15
    buffer_load_dwordx4 v16, s[40:43], s68 offen lds
    s_add_u32 m0, m0, 0x400
    s_nop 0
    buffer_load_dwordx4 v17, s[40:43], s68 offen lds
    s_add_u32 m0, m0, 0x400
    s_nop 0
    buffer_load_dwordx4 v18, s[40:43], s68 offen lds
    s_add_u32 m0, m0, 0x400
    s_nop 0
    buffer_load_dwordx4 v19, s[40:43], s68 offen lds
    v_and_b32 v20, 3, v144
    v_lshlrev_b32 v20, 2, v20
    s_waitcnt vmcnt(4) lgkmcnt(0)
    s_barrier
    s_xor_b32 s70, s3, 1
    s_xor_b32 s68, s10, 0
    s_lshl_b32 s69, s67, 12
    s_mul_i32 s68, s68, 2
    s_add_u32 m0, s69, 20480
    s_add_u32 s68, s68, s70
    s_lshl_b32 s68, s68, 15
    buffer_load_dwordx4 v16, s[40:43], s68 offen lds
    s_add_u32 m0, m0, 0x400
    s_nop 0
    buffer_load_dwordx4 v17, s[40:43], s68 offen lds
    s_add_u32 m0, m0, 0x400
    s_nop 0
    buffer_load_dwordx4 v18, s[40:43], s68 offen lds
    s_add_u32 m0, m0, 0x400
    s_nop 0
    buffer_load_dwordx4 v19, s[40:43], s68 offen lds
    s_add_u32 s70, s75, 0
    s_sub_u32 s73, s70, 7
    s_cselect_b32 s70, s70, s73
    s_xor_b32 s68, s10, 0
    s_lshl_b32 s69, s67, 12
    s_mul_i32 s68, s68, 7
    s_add_u32 m0, s69, 36864
    s_add_u32 s68, s68, s70
    s_lshl_b32 s68, s68, 15
    buffer_load_dwordx4 v16, s[36:39], s68 offen lds
    s_add_u32 m0, m0, 0x400
    s_nop 0
    buffer_load_dwordx4 v17, s[36:39], s68 offen lds
    s_add_u32 m0, m0, 0x400
    s_nop 0
    buffer_load_dwordx4 v18, s[36:39], s68 offen lds
    s_add_u32 m0, m0, 0x400
    s_nop 0
    buffer_load_dwordx4 v19, s[36:39], s68 offen lds
    s_add_u32 s70, s75, 1
    s_sub_u32 s73, s70, 7
    s_cselect_b32 s70, s70, s73
    s_xor_b32 s68, s10, 0
    s_lshl_b32 s69, s67, 12
    s_mul_i32 s68, s68, 7
    s_add_u32 m0, s69, 53248
    s_add_u32 s68, s68, s70
    s_lshl_b32 s68, s68, 15
    buffer_load_dwordx4 v16, s[36:39], s68 offen lds
    s_add_u32 m0, m0, 0x400
    s_nop 0
    buffer_load_dwordx4 v17, s[36:39], s68 offen lds
    s_add_u32 m0, m0, 0x400
    s_nop 0
    buffer_load_dwordx4 v18, s[36:39], s68 offen lds
    s_add_u32 m0, m0, 0x400
    s_nop 0
    buffer_load_dwordx4 v19, s[36:39], s68 offen lds
    s_mov_b32 s69, 262144
L_LW_1:
    ds_read_b32 v21, v20 offset:1552
    s_sub_u32 s69, s69, 1
    s_cbranch_scc1 L_LWX_2
    s_waitcnt lgkmcnt(0)
    v_cmp_ne_u32 vcc, 1, v21
    s_cbranch_vccnz L_LW_1
L_LWX_2:
    s_add_u32 s70, s75, 2
    s_sub_u32 s73, s70, 7
    s_cselect_b32 s70, s70, s73
    s_xor_b32 s68, s10, 0
    s_lshl_b32 s69, s67, 12
    s_mul_i32 s68, s68, 7
    s_add_u32 m0, s69, 69632
    s_add_u32 s68, s68, s70
    s_lshl_b32 s68, s68, 15
    buffer_load_dwordx4 v16, s[36:39], s68 offen lds
    s_add_u32 m0, m0, 0x400
    s_nop 0
    buffer_load_dwordx4 v17, s[36:39], s68 offen lds
    s_add_u32 m0, m0, 0x400
    s_nop 0
    buffer_load_dwordx4 v18, s[36:39], s68 offen lds
    s_add_u32 m0, m0, 0x400
    s_nop 0
    buffer_load_dwordx4 v19, s[36:39], s68 offen lds
    s_add_u32 s70, s75, 3
    s_sub_u32 s73, s70, 7
    s_cselect_b32 s70, s70, s73
    s_xor_b32 s68, s10, 0
    s_lshl_b32 s69, s67, 12
    s_mul_i32 s68, s68, 7
    s_add_u32 m0, s69, 86016
    s_add_u32 s68, s68, s70
    s_lshl_b32 s68, s68, 15
    buffer_load_dwordx4 v16, s[36:39], s68 offen lds
    s_add_u32 m0, m0, 0x400
    s_nop 0
    buffer_load_dwordx4 v17, s[36:39], s68 offen lds
    s_add_u32 m0, m0, 0x400
    s_nop 0
    buffer_load_dwordx4 v18, s[36:39], s68 offen lds
    s_add_u32 m0, m0, 0x400
    s_nop 0
    buffer_load_dwordx4 v19, s[36:39], s68 offen lds
    s_add_u32 s70, s75, 4
    s_sub_u32 s73, s70, 7
    s_cselect_b32 s70, s70, s73
    s_xor_b32 s68, s10, 0
    s_lshl_b32 s69, s67, 12
    s_mul_i32 s68, s68, 7
    s_add_u32 m0, s69, 102400
    s_add_u32 s68, s68, s70
    s_lshl_b32 s68, s68, 15
    buffer_load_dwordx4 v16, s[36:39], s68 offen lds
    s_add_u32 m0, m0, 0x400
    s_nop 0
    buffer_load_dwordx4 v17, s[36:39], s68 offen lds
    s_add_u32 m0, m0, 0x400
    s_nop 0
    buffer_load_dwordx4 v18, s[36:39], s68 offen lds
    s_add_u32 m0, m0, 0x400
    s_nop 0
    buffer_load_dwordx4 v19, s[36:39], s68 offen lds
    s_mov_b32 s69, 262144
L_LW_3:
    ds_read_b32 v21, v20 offset:1584
    s_sub_u32 s69, s69, 1
    s_cbranch_scc1 L_LWX_4
    s_waitcnt lgkmcnt(0)
    v_cmp_ne_u32 vcc, 1, v21
    s_cbranch_vccnz L_LW_3
L_LWX_4:
    s_add_u32 s70, s75, 5
    s_sub_u32 s73, s70, 7
    s_cselect_b32 s70, s70, s73
    s_xor_b32 s68, s10, 0
    s_lshl_b32 s69, s67, 12
    s_mul_i32 s68, s68, 7
    s_add_u32 m0, s69, 118784
    s_add_u32 s68, s68, s70
    s_lshl_b32 s68, s68, 15
    buffer_load_dwordx4 v16, s[36:39], s68 offen lds
    s_add_u32 m0, m0, 0x400
    s_nop 0
    buffer_load_dwordx4 v17, s[36:39], s68 offen lds
    s_add_u32 m0, m0, 0x400
    s_nop 0
    buffer_load_dwordx4 v18, s[36:39], s68 offen lds
    s_add_u32 m0, m0, 0x400
    s_nop 0
    buffer_load_dwordx4 v19, s[36:39], s68 offen lds
    s_add_u32 s70, s75, 6
    s_sub_u32 s73, s70, 7
    s_cselect_b32 s70, s70, s73
    s_xor_b32 s68, s10, 0
    s_lshl_b32 s69, s67, 12
    s_mul_i32 s68, s68, 7
    s_add_u32 m0, s69, 135168
    s_add_u32 s68, s68, s70
    s_lshl_b32 s68, s68, 15
    buffer_load_dwordx4 v16, s[36:39], s68 offen lds
    s_add_u32 m0, m0, 0x400
    s_nop 0
    buffer_load_dwordx4 v17, s[36:39], s68 offen lds
    s_add_u32 m0, m0, 0x400
    s_nop 0
    buffer_load_dwordx4 v18, s[36:39], s68 offen lds
    s_add_u32 m0, m0, 0x400
    s_nop 0
    buffer_load_dwordx4 v19, s[36:39], s68 offen lds
    s_lshr_b32 s68, s65, 1
    s_lshl_b32 s68, s68, 4
    s_add_u32 s68, s68, s10
    s_lshl_b32 s68, s68, 8
    s_and_b32 s70, s65, 1
    s_lshl_b32 s70, s70, 7
    s_add_u32 s68, s68, s70
    s_add_u32 s82, s68, 9502720
    v_and_b32 v159, 1, v144
    v_and_b32 v149, 2, v144
    v_lshlrev_b32 v159, 2, v159
    v_lshl_add_u32 v159, v149, 10, v159
    v_lshlrev_b32 v149, 4, v144
    s_mul_i32 s78, s65, 294912
    s_lshl_b32 s70, s10, 13
    s_add_u32 s79, s78, s70
    s_add_u32 s79, s79, 229376
    s_mul_i32 s70, s10, 28672
    s_add_u32 s78, s78, s70
    s_mov_b32 s56, s18
    s_mov_b32 s57, s19
    s_mov_b32 s58, 1024
    s_mov_b32 s59, 0x00020000
    s_waitcnt vmcnt(32)
    ds_read_b64_tr_b16 v[96:97], v145 offset:0
    ds_read_b64_tr_b16 v[98:99], v145 offset:2048
    ds_read_b64_tr_b16 v[100:101], v146 offset:0
    ds_read_b64_tr_b16 v[102:103], v146 offset:2048
    ds_read_b64_tr_b16 v[104:105], v147 offset:0
    ds_read_b64_tr_b16 v[106:107], v147 offset:2048
    ds_read_b64_tr_b16 v[108:109], v148 offset:0
    ds_read_b64_tr_b16 v[110:111], v148 offset:2048
    s_waitcnt lgkmcnt(0)
    s_xor_b32 s70, s3, 0
    s_xor_b32 s68, s10, 4
    s_lshl_b32 s69, s67, 12
    s_mul_i32 s68, s68, 2
    s_add_u32 m0, s69, 4096
    s_add_u32 s68, s68, s70
    s_lshl_b32 s68, s68, 15
    buffer_load_dwordx4 v16, s[40:43], s68 offen lds
    s_add_u32 m0, m0, 0x400
    s_nop 0
    buffer_load_dwordx4 v17, s[40:43], s68 offen lds
    s_add_u32 m0, m0, 0x400
    s_nop 0
    buffer_load_dwordx4 v18, s[40:43], s68 offen lds
    s_add_u32 m0, m0, 0x400
    s_nop 0
    buffer_load_dwordx4 v19, s[40:43], s68 offen lds
    s_waitcnt vmcnt(32)
    ds_read_b64_tr_b16 v[112:113], v145 offset:16384
    ds_read_b64_tr_b16 v[114:115], v145 offset:18432
    ds_read_b64_tr_b16 v[116:117], v146 offset:16384
    ds_read_b64_tr_b16 v[118:119], v146 offset:18432
    ds_read_b64_tr_b16 v[120:121], v147 offset:16384
    ds_read_b64_tr_b16 v[122:123], v147 offset:18432
    ds_read_b64_tr_b16 v[124:125], v148 offset:16384
    ds_read_b64_tr_b16 v[126:127], v148 offset:18432
    s_waitcnt lgkmcnt(0)
    s_xor_b32 s70, s3, 1
    s_xor_b32 s68, s10, 4
    s_lshl_b32 s69, s67, 12
    s_mul_i32 s68, s68, 2
    s_add_u32 m0, s69, 20480
    s_add_u32 s68, s68, s70
    s_lshl_b32 s68, s68, 15
    buffer_load_dwordx4 v16, s[40:43], s68 offen lds
    s_add_u32 m0, m0, 0x400
    s_nop 0
    buffer_load_dwordx4 v17, s[40:43], s68 offen lds
    s_add_u32 m0, m0, 0x400
    s_nop 0
    buffer_load_dwordx4 v18, s[40:43], s68 offen lds
    s_add_u32 m0, m0, 0x400
    s_nop 0
    buffer_load_dwordx4 v19, s[40:43], s68 offen lds
    s_waitcnt vmcnt(32)
    ds_read_b64_tr_b16 v[128:129], v145 offset:32768
    ds_read_b64_tr_b16 v[130:131], v145 offset:34816
    ds_read_b64_tr_b16 v[132:133], v146 offset:32768
    ds_read_b64_tr_b16 v[134:135], v146 offset:34816
    ds_read_b64_tr_b16 v[136:137], v147 offset:32768
    ds_read_b64_tr_b16 v[138:139], v147 offset:34816
    ds_read_b64_tr_b16 v[140:141], v148 offset:32768
    ds_read_b64_tr_b16 v[142:143], v148 offset:34816
    s_waitcnt lgkmcnt(0)
    s_add_u32 s70, s75, 0
    s_sub_u32 s73, s70, 7
    s_cselect_b32 s70, s70, s73
    s_xor_b32 s68, s10, 4
    s_lshl_b32 s69, s67, 12
    s_mul_i32 s68, s68, 7
    s_add_u32 m0, s69, 36864
    s_add_u32 s68, s68, s70
    s_lshl_b32 s68, s68, 15
    buffer_load_dwordx4 v16, s[36:39], s68 offen lds
    s_add_u32 m0, m0, 0x400
    s_nop 0
    buffer_load_dwordx4 v17, s[36:39], s68 offen lds
    s_add_u32 m0, m0, 0x400
    s_nop 0
    buffer_load_dwordx4 v18, s[36:39], s68 offen lds
    s_add_u32 m0, m0, 0x400
    s_nop 0
    buffer_load_dwordx4 v19, s[36:39], s68 offen lds
    s_waitcnt vmcnt(32)
    ds_read_b64_tr_b16 a[0:1], v145 offset:49152
    ds_read_b64_tr_b16 a[2:3], v145 offset:51200
    ds_read_b64_tr_b16 a[4:5], v146 offset:49152
    ds_read_b64_tr_b16 a[6:7], v146 offset:51200
    ds_read_b64_tr_b16 a[8:9], v147 offset:49152
    ds_read_b64_tr_b16 a[10:11], v147 offset:51200
    ds_read_b64_tr_b16 a[12:13], v148 offset:49152
    ds_read_b64_tr_b16 a[14:15], v148 offset:51200
    s_waitcnt lgkmcnt(0)
    s_add_u32 s70, s75, 1
    s_sub_u32 s73, s70, 7
    s_cselect_b32 s70, s70, s73
    s_xor_b32 s68, s10, 4
    s_lshl_b32 s69, s67, 12
    s_mul_i32 s68, s68, 7
    s_add_u32 m0, s69, 53248
    s_add_u32 s68, s68, s70
    s_lshl_b32 s68, s68, 15
    buffer_load_dwordx4 v16, s[36:39], s68 offen lds
    s_add_u32 m0, m0, 0x400
    s_nop 0
    buffer_load_dwordx4 v17, s[36:39], s68 offen lds
    s_add_u32 m0, m0, 0x400
    s_nop 0
    buffer_load_dwordx4 v18, s[36:39], s68 offen lds
    s_add_u32 m0, m0, 0x400
    s_nop 0
    buffer_load_dwordx4 v19, s[36:39], s68 offen lds
    s_waitcnt vmcnt(32)
    v_add_u32 v145, 0x10000, v145
    v_add_u32 v146, 0x10000, v146
    v_add_u32 v147, 0x10000, v147
    v_add_u32 v148, 0x10000, v148
    ds_read_b64_tr_b16 a[16:17], v145 offset:0
    ds_read_b64_tr_b16 a[18:19], v145 offset:2048
    ds_read_b64_tr_b16 a[20:21], v146 offset:0
    ds_read_b64_tr_b16 a[22:23], v146 offset:2048
    ds_read_b64_tr_b16 a[24:25], v147 offset:0
    ds_read_b64_tr_b16 a[26:27], v147 offset:2048
    ds_read_b64_tr_b16 a[28:29], v148 offset:0
    ds_read_b64_tr_b16 a[30:31], v148 offset:2048
    s_waitcnt lgkmcnt(0)
    s_add_u32 s70, s75, 2
    s_sub_u32 s73, s70, 7
    s_cselect_b32 s70, s70, s73
    s_xor_b32 s68, s10, 4
    s_lshl_b32 s69, s67, 12
    s_mul_i32 s68, s68, 7
    s_add_u32 m0, s69, 69632
    s_add_u32 s68, s68, s70
    s_lshl_b32 s68, s68, 15
    buffer_load_dwordx4 v16, s[36:39], s68 offen lds
    s_add_u32 m0, m0, 0x400
    s_nop 0
    buffer_load_dwordx4 v17, s[36:39], s68 offen lds
    s_add_u32 m0, m0, 0x400
    s_nop 0
    buffer_load_dwordx4 v18, s[36:39], s68 offen lds
    s_add_u32 m0, m0, 0x400
    s_nop 0
    buffer_load_dwordx4 v19, s[36:39], s68 offen lds
    s_waitcnt vmcnt(32)
    ds_read_b64_tr_b16 a[32:33], v145 offset:16384
    ds_read_b64_tr_b16 a[34:35], v145 offset:18432
    ds_read_b64_tr_b16 a[36:37], v146 offset:16384
    ds_read_b64_tr_b16 a[38:39], v146 offset:18432
    ds_read_b64_tr_b16 a[40:41], v147 offset:16384
    ds_read_b64_tr_b16 a[42:43], v147 offset:18432
    ds_read_b64_tr_b16 a[44:45], v148 offset:16384
    ds_read_b64_tr_b16 a[46:47], v148 offset:18432
    s_waitcnt lgkmcnt(0)
    s_add_u32 s70, s75, 3
    s_sub_u32 s73, s70, 7
    s_cselect_b32 s70, s70, s73
    s_xor_b32 s68, s10, 4
    s_lshl_b32 s69, s67, 12
    s_mul_i32 s68, s68, 7
    s_add_u32 m0, s69, 86016
    s_add_u32 s68, s68, s70
    s_lshl_b32 s68, s68, 15
    buffer_load_dwordx4 v16, s[36:39], s68 offen lds
    s_add_u32 m0, m0, 0x400
    s_nop 0
    buffer_load_dwordx4 v17, s[36:39], s68 offen lds
    s_add_u32 m0, m0, 0x400
    s_nop 0
    buffer_load_dwordx4 v18, s[36:39], s68 offen lds
    s_add_u32 m0, m0, 0x400
    s_nop 0
    buffer_load_dwordx4 v19, s[36:39], s68 offen lds
    s_waitcnt vmcnt(32)
    ds_read_b64_tr_b16 a[48:49], v145 offset:32768
    ds_read_b64_tr_b16 a[50:51], v145 offset:34816
    ds_read_b64_tr_b16 a[52:53], v146 offset:32768
    ds_read_b64_tr_b16 a[54:55], v146 offset:34816
    ds_read_b64_tr_b16 a[56:57], v147 offset:32768
    ds_read_b64_tr_b16 a[58:59], v147 offset:34816
    ds_read_b64_tr_b16 a[60:61], v148 offset:32768
    ds_read_b64_tr_b16 a[62:63], v148 offset:34816
    buffer_load_dword v157, v159, s[44:47], s82 offen sc1
    s_waitcnt lgkmcnt(0)
    s_add_u32 s70, s75, 4
    s_sub_u32 s73, s70, 7
    s_cselect_b32 s70, s70, s73
    s_xor_b32 s68, s10, 4
    s_lshl_b32 s69, s67, 12
    s_mul_i32 s68, s68, 7
    s_add_u32 m0, s69, 102400
    s_add_u32 s68, s68, s70
    s_lshl_b32 s68, s68, 15
    buffer_load_dwordx4 v16, s[36:39], s68 offen lds
    s_add_u32 m0, m0, 0x400
    s_nop 0
    buffer_load_dwordx4 v17, s[36:39], s68 offen lds
    s_add_u32 m0, m0, 0x400
    s_nop 0
    buffer_load_dwordx4 v18, s[36:39], s68 offen lds
    s_add_u32 m0, m0, 0x400
    s_nop 0
    buffer_load_dwordx4 v19, s[36:39], s68 offen lds
    s_waitcnt vmcnt(33)
    ds_read_b64_tr_b16 a[64:65], v145 offset:49152
    ds_read_b64_tr_b16 a[66:67], v145 offset:51200
    ds_read_b64_tr_b16 a[68:69], v146 offset:49152
    ds_read_b64_tr_b16 a[70:71], v146 offset:51200
    ds_read_b64_tr_b16 a[72:73], v147 offset:49152
    ds_read_b64_tr_b16 a[74:75], v147 offset:51200
    ds_read_b64_tr_b16 a[76:77], v148 offset:49152
    ds_read_b64_tr_b16 a[78:79], v148 offset:51200
    s_waitcnt lgkmcnt(0)
    s_add_u32 s70, s75, 5
    s_sub_u32 s73, s70, 7
    s_cselect_b32 s70, s70, s73
    s_xor_b32 s68, s10, 4
    s_lshl_b32 s69, s67, 12
    s_mul_i32 s68, s68, 7
    s_add_u32 m0, s69, 118784
    s_add_u32 s68, s68, s70
    s_lshl_b32 s68, s68, 15
    buffer_load_dwordx4 v16, s[36:39], s68 offen lds
    s_add_u32 m0, m0, 0x400
    s_nop 0
    buffer_load_dwordx4 v17, s[36:39], s68 offen lds
    s_add_u32 m0, m0, 0x400
    s_nop 0
    buffer_load_dwordx4 v18, s[36:39], s68 offen lds
    s_add_u32 m0, m0, 0x400
    s_nop 0
    buffer_load_dwordx4 v19, s[36:39], s68 offen lds
    s_waitcnt vmcnt(33)
    v_add_u32 v145, 0x10000, v145
    v_add_u32 v146, 0x10000, v146
    v_add_u32 v147, 0x10000, v147
    v_add_u32 v148, 0x10000, v148
    ds_read_b64_tr_b16 a[80:81], v145 offset:0
    ds_read_b64_tr_b16 a[82:83], v145 offset:2048
    ds_read_b64_tr_b16 a[84:85], v146 offset:0
    ds_read_b64_tr_b16 a[86:87], v146 offset:2048
    ds_read_b64_tr_b16 a[88:89], v147 offset:0
    ds_read_b64_tr_b16 a[90:91], v147 offset:2048
    ds_read_b64_tr_b16 a[92:93], v148 offset:0
    ds_read_b64_tr_b16 a[94:95], v148 offset:2048
    s_waitcnt lgkmcnt(0)
    s_add_u32 s70, s75, 6
    s_sub_u32 s73, s70, 7
    s_cselect_b32 s70, s70, s73
    s_xor_b32 s68, s10, 4
    s_lshl_b32 s69, s67, 12
    s_mul_i32 s68, s68, 7
    s_add_u32 m0, s69, 135168
    s_add_u32 s68, s68, s70
    s_lshl_b32 s68, s68, 15
    buffer_load_dwordx4 v16, s[36:39], s68 offen lds
    s_add_u32 m0, m0, 0x400
    s_nop 0
    buffer_load_dwordx4 v17, s[36:39], s68 offen lds
    s_add_u32 m0, m0, 0x400
    s_nop 0
    buffer_load_dwordx4 v18, s[36:39], s68 offen lds
    s_add_u32 m0, m0, 0x400
    s_nop 0
    buffer_load_dwordx4 v19, s[36:39], s68 offen lds
    s_lshl_b32 s68, s67, 2
    v_mov_b32 v24, s68
    v_mov_b32 v25, 1
    s_waitcnt vmcnt(12)
    v_cmp_ne_u32 vcc, s11, v157
    s_and_b32 s68, vcc_lo, 12
    s_cbranch_scc1 L_LSLOW
    s_and_b32 s77, vcc_lo, 3
    s_xor_b32 s71, s3, 0
    s_lshl_b32 s71, s71, 12
    s_add_u32 s71, s71, s79
    buffer_load_dwordx4 v[64:67], v149, s[44:47], s71 offen offset:0 sc1
    buffer_load_dwordx4 v[68:71], v149, s[44:47], s71 offen offset:1024 sc1
    buffer_load_dwordx4 v[72:75], v149, s[44:47], s71 offen offset:2048 sc1
    buffer_load_dwordx4 v[76:79], v149, s[44:47], s71 offen offset:3072 sc1
    s_xor_b32 s71, s3, 1
    s_lshl_b32 s71, s71, 12
    s_add_u32 s71, s71, s79
    buffer_load_dwordx4 v[80:83], v149, s[44:47], s71 offen offset:0 sc1
    buffer_load_dwordx4 v[84:87], v149, s[44:47], s71 offen offset:1024 sc1
    buffer_load_dwordx4 v[88:91], v149, s[44:47], s71 offen offset:2048 sc1
    buffer_load_dwordx4 v[92:95], v149, s[44:47], s71 offen offset:3072 sc1
    s_waitcnt vmcnt(8)
    ds_write_b32 v24, v25 offset:1536
    s_setprio 0
    s_branch L_P2B
L_LSLOW:
    s_setprio 0
    buffer_load_dword v157, v159, s[44:47], s82 offen sc1
    s_waitcnt vmcnt(1)
    ds_write_b32 v24, v25 offset:1536
    s_waitcnt vmcnt(0)
    s_branch L_P2
L_COMPUTE:
    s_setprio 1
    s_xor_b32 s68, s65, s66
    s_and_b32 s68, s68, 1
    s_lshl_b32 s68, s68, 2
    s_xor_b32 s10, s60, s68
    s_bfe_u32 s3, s65, 0x10001
    s_mul_i32 s68, s3, 0
    s_mul_i32 s75, s66, 1
    s_add_u32 s75, s75, s68
    s_lshr_b32 s68, s65, 2
    s_mul_i32 s68, s68, 3
    s_add_u32 s75, s75, s68
    s_mul_i32 s68, s75, 37
    s_lshr_b32 s68, s68, 8
    s_mul_i32 s68, s68, 7
    s_sub_u32 s75, s75, s68
    s_mov_b32 s44, s26
    s_mov_b32 s45, s27
    s_mov_b32 s46, 0x920000
    s_mov_b32 s47, 0x00020000
    s_mov_b32 s52, s24
    s_mov_b32 s53, s25
    s_mov_b32 s54, 256
    s_mov_b32 s55, 0x00020000
    s_mov_b32 s48, s22
    s_mov_b32 s49, s23
    s_mov_b32 s50, 2097152
    s_mov_b32 s51, 0x00020000
    s_lshr_b32 s84, s67, 1
    s_and_b32 s85, s67, 1
    v_lshrrev_b32 v151, 4, v144
    s_cmp_eq_u32 s63, 1
    s_cbranch_scc1 L_NOB1
    s_mov_b32 s56, s14
    s_mov_b32 s57, s15
    s_mov_b32 s58, 3584
    s_mov_b32 s59, 0x00020000
    s_mul_i32 s68, s62, 448
    s_lshl_b32 s69, s85, 8
    s_add_u32 s69, s69, s68
    s_lshl_b32 s70, s85, 5
    s_add_u32 s70, s70, s68
    v_lshlrev_b32 v155, 3, v151
    buffer_load_dwordx2 v[112:113], v155, s[56:59], s69 offen offset:0
    buffer_load_dwordx2 v[114:115], v155, s[56:59], s69 offen offset:32
    buffer_load_dwordx2 v[116:117], v155, s[56:59], s69 offen offset:64
    buffer_load_dwordx2 v[118:119], v155, s[56:59], s69 offen offset:96
    buffer_load_dwordx2 v[120:121], v155, s[56:59], s69 offen offset:128
    buffer_load_dwordx2 v[122:123], v155, s[56:59], s69 offen offset:160
    buffer_load_dwordx2 v[124:125], v155, s[56:59], s70 offen offset:192
L_NOB1:
    s_cmp_lg_u32 s67, 0
    s_cbranch_scc1 L_NOZLD
    s_lshl_b32 s68, s61, 1
    s_add_u32 s68, s68, s63
    s_lshl_b32 s68, s68, 1
    s_lshr_b32 s69, s62, 2
    s_add_u32 s68, s68, s69
    s_lshl_b32 s68, s68, 1
    s_and_b32 s69, s62, 1
    s_add_u32 s68, s68, s69
    s_lshl_b32 s68, s68, 4
    s_bfe_u32 s69, s62, 0x10001
    s_add_u32 s68, s68, s69
    s_lshl_b32 s68, s68, 10
    v_lshlrev_b32 v1, 4, v144
    s_mov_b32 s32, s20
    s_mov_b32 s33, s21
    s_mov_b32 s34, 1024
    s_mov_b32 s35, 0x00020000
    buffer_load_dwordx4 v[16:19], v1, s[28:31], s68 offen offset:0
    buffer_load_dwordx4 v[20:23], v1, s[28:31], s68 offen offset:2048
    s_add_u32 s68, s68, 4096
    buffer_load_dwordx4 v[24:27], v1, s[28:31], s68 offen offset:0
    buffer_load_dwordx4 v[28:31], v1, s[28:31], s68 offen offset:2048
    s_add_u32 s68, s68, 4096
    buffer_load_dwordx4 v[32:35], v1, s[28:31], s68 offen offset:0
    buffer_load_dwordx4 v[36:39], v1, s[28:31], s68 offen offset:2048
    s_add_u32 s68, s68, 4096
    buffer_load_dwordx4 v[40:43], v1, s[28:31], s68 offen offset:0
    buffer_load_dwordx4 v[44:47], v1, s[28:31], s68 offen offset:2048
    buffer_load_dwordx4 v[12:15], v1, s[32:35], 0 offen
L_NOZLD:
    s_lshl_b32 s68, s61, 4
    s_lshl_b32 s69, s63, 3
    s_add_u32 s68, s68, s69
    s_add_u32 s77, s68, s62
    s_cmp_lg_u32 s67, 0
    s_cbranch_scc1 L_NOCLR
    v_mov_b32 v2, 0
    v_lshlrev_b32 v1, 2, v144
    s_mov_b64 exec, 0xffff
    ds_write_b32 v1, v2 offset:1536
    s_mov_b64 exec, -1
    v_mov_b32 v4, 0
    v_mov_b32 v5, 0
    v_mov_b32 v6, 0
    v_mov_b32 v7, 0
    v_mov_b32 v8, 0
    v_mov_b32 v9, 0
    v_mov_b32 v10, 0
    v_mov_b32 v11, 0
    v_lshrrev_b32 v1, 1, v144
    s_waitcnt vmcnt(0)
    v_dot2c_f32_bf16 v4, v16, v12
    v_dot2c_f32_bf16 v5, v20, v12
    v_dot2c_f32_bf16 v6, v24, v12
    v_dot2c_f32_bf16 v7, v28, v12
    v_dot2c_f32_bf16 v8, v32, v12
    v_dot2c_f32_bf16 v9, v36, v12
    v_dot2c_f32_bf16 v10, v40, v12
    v_dot2c_f32_bf16 v11, v44, v12
    v_dot2c_f32_bf16 v4, v17, v13
    v_dot2c_f32_bf16 v5, v21, v13
    v_dot2c_f32_bf16 v6, v25, v13
    v_dot2c_f32_bf16 v7, v29, v13
    v_dot2c_f32_bf16 v8, v33, v13
    v_dot2c_f32_bf16 v9, v37, v13
    v_dot2c_f32_bf16 v10, v41, v13
    v_dot2c_f32_bf16 v11, v45, v13
    v_dot2c_f32_bf16 v4, v18, v14
    v_dot2c_f32_bf16 v5, v22, v14
    v_dot2c_f32_bf16 v6, v26, v14
    v_dot2c_f32_bf16 v7, v30, v14
    v_dot2c_f32_bf16 v8, v34, v14
    v_dot2c_f32_bf16 v9, v38, v14
    v_dot2c_f32_bf16 v10, v42, v14
    v_dot2c_f32_bf16 v11, v46, v14
    v_dot2c_f32_bf16 v4, v19, v15
    v_dot2c_f32_bf16 v5, v23, v15
    v_dot2c_f32_bf16 v6, v27, v15
    v_dot2c_f32_bf16 v7, v31, v15
    v_dot2c_f32_bf16 v8, v35, v15
    v_dot2c_f32_bf16 v9, v39, v15
    v_dot2c_f32_bf16 v10, v43, v15
    v_dot2c_f32_bf16 v11, v47, v15
    s_nop 2
    v_permlane32_swap_b32 v4, v8
    v_permlane32_swap_b32 v5, v9
    v_permlane32_swap_b32 v6, v10
    v_permlane32_swap_b32 v7, v11
    s_nop 1
    v_add_f32 v4, v4, v8
    v_add_f32 v5, v5, v9
    v_add_f32 v6, v6, v10
    v_add_f32 v7, v7, v11
    s_nop 1
    v_permlane16_swap_b32 v4, v6
    v_permlane16_swap_b32 v5, v7
    s_nop 1
    v_add_f32 v4, v4, v6
    v_add_f32 v5, v5, v7
    s_nop 1
    v_add_f32_dpp v6, v4, v4 row_ror:8 row_mask:0xf bank_mask:0x3
    v_add_f32_dpp v6, v5, v5 row_ror:8 row_mask:0xf bank_mask:0xc
    s_nop 1
    v_add_f32_dpp v6, v6, v6 quad_perm:[1,0,3,2] row_mask:0xf bank_mask:0xf
    s_nop 1
    v_add_f32_dpp v6, v6, v6 quad_perm:[2,3,0,1] row_mask:0xf bank_mask:0xf
    s_nop 1
    v_add_f32_dpp v6, v6, v6 row_half_mirror row_mask:0xf bank_mask:0xf
    s_mov_b32 s70, 0x01010101
    s_mov_b32 s71, 0x01010101
    s_mov_b64 exec, s[70:71]
    ds_write_b32 v1, v6 offset:0
    s_mov_b64 exec, -1
L_NOCLR:
    v_and_b32 v150, 15, v144
    v_bfe_u32 v152, v144, 2, 2
    v_and_b32 v153, 3, v144
    v_lshrrev_b32 v154, 1, v150
    v_xor_b32 v154, v154, v151
    s_lshl_b32 s68, s84, 13
    s_add_u32 s68, s68, 73728
    v_lshl_add_u32 v128, v150, 7, s68
    v_lshl_add_u32 v128, v154, 4, v128
    v_xor_b32 v129, 64, v128
    s_lshl_b32 s68, s67, 2
    v_mov_b32 v134, s68
    v_mov_b32 v135, 1
    s_mov_b32 s74, 73728
    s_cmp_eq_u32 s63, 1
    s_cbranch_scc1 L_C_ATT
    s_movk_i32 s68, 448
    v_lshl_add_u32 v155, v151, 3, v152
    v_mul_u32_u24 v155, s68, v155
    v_lshl_add_u32 v155, v153, 3, v155
    v_add_u32 v155, 90112, v155
    v_and_b32 v156, 1, v151
    s_lshl_b32 s69, s85, 8
    v_lshl_add_u32 v130, v156, 5, v155
    v_add_u32 v130, s69, v130
    v_xor_b32 v157, 1, v156
    v_lshl_add_u32 v131, v157, 5, v155
    v_add_u32 v131, s69, v131
    v_xor_b32 v157, s85, v156
    v_lshl_add_u32 v132, v157, 5, v155
    s_cmp_eq_u32 s67, 0
    s_cbranch_scc1 L_B1OK
    s_waitcnt vmcnt(0)
L_B1OK:
    v_lshlrev_b32 v0, 16, v112
    v_and_b32 v1, 0xffff0000, v112
    v_lshlrev_b32 v2, 16, v113
    v_and_b32 v3, 0xffff0000, v113
    v_lshlrev_b32 v4, 16, v112
    v_and_b32 v5, 0xffff0000, v112
    v_lshlrev_b32 v6, 16, v113
    v_and_b32 v7, 0xffff0000, v113
    v_lshlrev_b32 v8, 16, v112
    v_and_b32 v9, 0xffff0000, v112
    v_lshlrev_b32 v10, 16, v113
    v_and_b32 v11, 0xffff0000, v113
    v_lshlrev_b32 v12, 16, v112
    v_and_b32 v13, 0xffff0000, v112
    v_lshlrev_b32 v14, 16, v113
    v_and_b32 v15, 0xffff0000, v113
    v_lshlrev_b32 v16, 16, v114
    v_and_b32 v17, 0xffff0000, v114
    v_lshlrev_b32 v18, 16, v115
    v_and_b32 v19, 0xffff0000, v115
    v_lshlrev_b32 v20, 16, v114
    v_and_b32 v21, 0xffff0000, v114
    v_lshlrev_b32 v22, 16, v115
    v_and_b32 v23, 0xffff0000, v115
    v_lshlrev_b32 v24, 16, v114
    v_and_b32 v25, 0xffff0000, v114
    v_lshlrev_b32 v26, 16, v115
    v_and_b32 v27, 0xffff0000, v115
    v_lshlrev_b32 v28, 16, v114
    v_and_b32 v29, 0xffff0000, v114
    v_lshlrev_b32 v30, 16, v115
    v_and_b32 v31, 0xffff0000, v115
    v_lshlrev_b32 v32, 16, v116
    v_and_b32 v33, 0xffff0000, v116
    v_lshlrev_b32 v34, 16, v117
    v_and_b32 v35, 0xffff0000, v117
    v_lshlrev_b32 v36, 16, v116
    v_and_b32 v37, 0xffff0000, v116
    v_lshlrev_b32 v38, 16, v117
    v_and_b32 v39, 0xffff0000, v117
    v_lshlrev_b32 v40, 16, v116
    v_and_b32 v41, 0xffff0000, v116
    v_lshlrev_b32 v42, 16, v117
    v_and_b32 v43, 0xffff0000, v117
    v_lshlrev_b32 v44, 16, v116
    v_and_b32 v45, 0xffff0000, v116
    v_lshlrev_b32 v46, 16, v117
    v_and_b32 v47, 0xffff0000, v117
    v_lshlrev_b32 v48, 16, v118
    v_and_b32 v49, 0xffff0000, v118
    v_lshlrev_b32 v50, 16, v119
    v_and_b32 v51, 0xffff0000, v119
    v_lshlrev_b32 v52, 16, v118
    v_and_b32 v53, 0xffff0000, v118
    v_lshlrev_b32 v54, 16, v119
    v_and_b32 v55, 0xffff0000, v119
    v_lshlrev_b32 v56, 16, v118
    v_and_b32 v57, 0xffff0000, v118
    v_lshlrev_b32 v58, 16, v119
    v_and_b32 v59, 0xffff0000, v119
    v_lshlrev_b32 v60, 16, v118
    v_and_b32 v61, 0xffff0000, v118
    v_lshlrev_b32 v62, 16, v119
    v_and_b32 v63, 0xffff0000, v119
    v_lshlrev_b32 v64, 16, v120
    v_and_b32 v65, 0xffff0000, v120
    v_lshlrev_b32 v66, 16, v121
    v_and_b32 v67, 0xffff0000, v121
    v_lshlrev_b32 v68, 16, v120
    v_and_b32 v69, 0xffff0000, v120
    v_lshlrev_b32 v70, 16, v121
    v_and_b32 v71, 0xffff0000, v121
    v_lshlrev_b32 v72, 16, v120
    v_and_b32 v73, 0xffff0000, v120
    v_lshlrev_b32 v74, 16, v121
    v_and_b32 v75, 0xffff0000, v121
    v_lshlrev_b32 v76, 16, v120
    v_and_b32 v77, 0xffff0000, v120
    v_lshlrev_b32 v78, 16, v121
    v_and_b32 v79, 0xffff0000, v121
    v_lshlrev_b32 v80, 16, v122
    v_and_b32 v81, 0xffff0000, v122
    v_lshlrev_b32 v82, 16, v123
    v_and_b32 v83, 0xffff0000, v123
    v_lshlrev_b32 v84, 16, v122
    v_and_b32 v85, 0xffff0000, v122
    v_lshlrev_b32 v86, 16, v123
    v_and_b32 v87, 0xffff0000, v123
    v_lshlrev_b32 v88, 16, v122
    v_and_b32 v89, 0xffff0000, v122
    v_lshlrev_b32 v90, 16, v123
    v_and_b32 v91, 0xffff0000, v123
    v_lshlrev_b32 v92, 16, v122
    v_and_b32 v93, 0xffff0000, v122
    v_lshlrev_b32 v94, 16, v123
    v_and_b32 v95, 0xffff0000, v123
    v_lshlrev_b32 v96, 16, v124
    v_and_b32 v97, 0xffff0000, v124
    v_lshlrev_b32 v98, 16, v125
    v_and_b32 v99, 0xffff0000, v125
    v_lshlrev_b32 v100, 16, v124
    v_and_b32 v101, 0xffff0000, v124
    v_lshlrev_b32 v102, 16, v125
    v_and_b32 v103, 0xffff0000, v125
    v_lshlrev_b32 v104, 16, v124
    v_and_b32 v105, 0xffff0000, v124
    v_lshlrev_b32 v106, 16, v125
    v_and_b32 v107, 0xffff0000, v125
    v_lshlrev_b32 v108, 16, v124
    v_and_b32 v109, 0xffff0000, v124
    v_lshlrev_b32 v110, 16, v125
    v_and_b32 v111, 0xffff0000, v125
    s_waitcnt lgkmcnt(0)
    s_setprio 0
    s_barrier
    ds_read_b128 a[0:3], v128 offset:0
    ds_read_b128 a[4:7], v129 offset:2048
    ds_read_b128 a[8:11], v128 offset:4096
    ds_read_b128 a[12:15], v129 offset:6144
    ds_read_b64_tr_b16 a[16:17], v130 offset:0
    ds_read_b64_tr_b16 a[18:19], v130 offset:1792
    ds_read_b64_tr_b16 a[20:21], v131 offset:0
    ds_read_b64_tr_b16 a[22:23], v131 offset:1792
    ds_read_b64_tr_b16 a[24:25], v130 offset:64
    ds_read_b64_tr_b16 a[26:27], v130 offset:1856
    ds_read_b64_tr_b16 a[28:29], v131 offset:64
    ds_read_b64_tr_b16 a[30:31], v131 offset:1856
    ds_read_b64_tr_b16 a[32:33], v130 offset:128
    ds_read_b64_tr_b16 a[34:35], v130 offset:1920
    ds_read_b64_tr_b16 a[36:37], v131 offset:128
    ds_read_b64_tr_b16 a[38:39], v131 offset:1920
    ds_read_b64_tr_b16 a[40:41], v132 offset:192
    ds_read_b64_tr_b16 a[42:43], v132 offset:1984
    s_mov_b32 s83, 8
L_FLOOP:
    s_waitcnt lgkmcnt(0)
    v_mfma_f32_16x16x32_bf16 v[0:3], a[16:19], a[0:3], v[0:3]
    ds_read_b128 a[44:47], v129 offset:0
    v_mfma_f32_16x16x32_bf16 v[4:7], a[16:19], a[4:7], v[4:7]
    ds_read_b128 a[48:51], v128 offset:2048
    v_mfma_f32_16x16x32_bf16 v[8:11], a[16:19], a[8:11], v[8:11]
    ds_read_b128 a[52:55], v129 offset:4096
    v_mfma_f32_16x16x32_bf16 v[12:15], a[16:19], a[12:15], v[12:15]
    ds_read_b128 a[56:59], v128 offset:6144
    v_mfma_f32_16x16x32_bf16 v[16:19], a[20:23], a[0:3], v[16:19]
    ds_read_b64_tr_b16 a[60:61], v130 offset:14336
    v_mfma_f32_16x16x32_bf16 v[20:23], a[20:23], a[4:7], v[20:23]
    ds_read_b64_tr_b16 a[62:63], v130 offset:16128
    v_mfma_f32_16x16x32_bf16 v[24:27], a[20:23], a[8:11], v[24:27]
    ds_read_b64_tr_b16 a[64:65], v131 offset:14336
    v_mfma_f32_16x16x32_bf16 v[28:31], a[20:23], a[12:15], v[28:31]
    ds_read_b64_tr_b16 a[66:67], v131 offset:16128
    v_mfma_f32_16x16x32_bf16 v[32:35], a[24:27], a[0:3], v[32:35]
    ds_read_b64_tr_b16 a[68:69], v130 offset:14400
    v_mfma_f32_16x16x32_bf16 v[36:39], a[24:27], a[4:7], v[36:39]
    ds_read_b64_tr_b16 a[70:71], v130 offset:16192
    v_mfma_f32_16x16x32_bf16 v[40:43], a[24:27], a[8:11], v[40:43]
    ds_read_b64_tr_b16 a[72:73], v131 offset:14400
    v_mfma_f32_16x16x32_bf16 v[44:47], a[24:27], a[12:15], v[44:47]
    ds_read_b64_tr_b16 a[74:75], v131 offset:16192
    v_mfma_f32_16x16x32_bf16 v[48:51], a[28:31], a[0:3], v[48:51]
    ds_read_b64_tr_b16 a[76:77], v130 offset:14464
    v_mfma_f32_16x16x32_bf16 v[52:55], a[28:31], a[4:7], v[52:55]
    ds_read_b64_tr_b16 a[78:79], v130 offset:16256
    v_mfma_f32_16x16x32_bf16 v[56:59], a[28:31], a[8:11], v[56:59]
    ds_read_b64_tr_b16 a[80:81], v131 offset:14464
    v_mfma_f32_16x16x32_bf16 v[60:63], a[28:31], a[12:15], v[60:63]
    ds_read_b64_tr_b16 a[82:83], v131 offset:16256
    v_mfma_f32_16x16x32_bf16 v[64:67], a[32:35], a[0:3], v[64:67]
    ds_read_b64_tr_b16 a[84:85], v132 offset:14528
    v_mfma_f32_16x16x32_bf16 v[68:71], a[32:35], a[4:7], v[68:71]
    ds_read_b64_tr_b16 a[86:87], v132 offset:16320
    v_mfma_f32_16x16x32_bf16 v[72:75], a[32:35], a[8:11], v[72:75]
    v_mfma_f32_16x16x32_bf16 v[76:79], a[32:35], a[12:15], v[76:79]
    v_mfma_f32_16x16x32_bf16 v[80:83], a[36:39], a[0:3], v[80:83]
    s_add_u32 s72, s74, 45056
    s_cmp_gt_u32 s72, 118784
    s_cselect_b32 s72, 28672, s72
    s_sub_u32 s73, s72, s74
    s_mov_b32 s74, s72
    s_sub_u32 s83, s83, 1
    v_mfma_f32_16x16x32_bf16 v[84:87], a[36:39], a[4:7], v[84:87]
    v_add_u32 v128, s73, v128
    v_mfma_f32_16x16x32_bf16 v[88:91], a[36:39], a[8:11], v[88:91]
    v_add_u32 v129, s73, v129
    v_mfma_f32_16x16x32_bf16 v[92:95], a[36:39], a[12:15], v[92:95]
    v_add_u32 v130, s73, v130
    v_mfma_f32_16x16x32_bf16 v[96:99], a[40:43], a[0:3], v[96:99]
    v_add_u32 v131, s73, v131
    v_mfma_f32_16x16x32_bf16 v[100:103], a[40:43], a[4:7], v[100:103]
    v_add_u32 v132, s73, v132
    v_mfma_f32_16x16x32_bf16 v[104:107], a[40:43], a[8:11], v[104:107]
    v_mfma_f32_16x16x32_bf16 v[108:111], a[40:43], a[12:15], v[108:111]
    s_waitcnt lgkmcnt(0)
    s_cmp_le_u32 s83, 1
    s_cbranch_scc1 L_FLOOP_SIG
    s_barrier
L_FLOOP_BACK:
    v_mfma_f32_16x16x32_bf16 v[0:3], a[60:63], a[44:47], v[0:3]
    ds_read_b128 a[0:3], v128 offset:0
    v_mfma_f32_16x16x32_bf16 v[4:7], a[60:63], a[48:51], v[4:7]
    ds_read_b128 a[4:7], v129 offset:2048
    v_mfma_f32_16x16x32_bf16 v[8:11], a[60:63], a[52:55], v[8:11]
    ds_read_b128 a[8:11], v128 offset:4096
    v_mfma_f32_16x16x32_bf16 v[12:15], a[60:63], a[56:59], v[12:15]
    ds_read_b128 a[12:15], v129 offset:6144
    v_mfma_f32_16x16x32_bf16 v[16:19], a[64:67], a[44:47], v[16:19]
    ds_read_b64_tr_b16 a[16:17], v130 offset:0
    v_mfma_f32_16x16x32_bf16 v[20:23], a[64:67], a[48:51], v[20:23]
    ds_read_b64_tr_b16 a[18:19], v130 offset:1792
    v_mfma_f32_16x16x32_bf16 v[24:27], a[64:67], a[52:55], v[24:27]
    ds_read_b64_tr_b16 a[20:21], v131 offset:0
    v_mfma_f32_16x16x32_bf16 v[28:31], a[64:67], a[56:59], v[28:31]
    ds_read_b64_tr_b16 a[22:23], v131 offset:1792
    v_mfma_f32_16x16x32_bf16 v[32:35], a[68:71], a[44:47], v[32:35]
    ds_read_b64_tr_b16 a[24:25], v130 offset:64
    v_mfma_f32_16x16x32_bf16 v[36:39], a[68:71], a[48:51], v[36:39]
    ds_read_b64_tr_b16 a[26:27], v130 offset:1856
    v_mfma_f32_16x16x32_bf16 v[40:43], a[68:71], a[52:55], v[40:43]
    ds_read_b64_tr_b16 a[28:29], v131 offset:64
    v_mfma_f32_16x16x32_bf16 v[44:47], a[68:71], a[56:59], v[44:47]
    ds_read_b64_tr_b16 a[30:31], v131 offset:1856
    v_mfma_f32_16x16x32_bf16 v[48:51], a[72:75], a[44:47], v[48:51]
    ds_read_b64_tr_b16 a[32:33], v130 offset:128
    v_mfma_f32_16x16x32_bf16 v[52:55], a[72:75], a[48:51], v[52:55]
    ds_read_b64_tr_b16 a[34:35], v130 offset:1920
    v_mfma_f32_16x16x32_bf16 v[56:59], a[72:75], a[52:55], v[56:59]
    ds_read_b64_tr_b16 a[36:37], v131 offset:128
    v_mfma_f32_16x16x32_bf16 v[60:63], a[72:75], a[56:59], v[60:63]
    ds_read_b64_tr_b16 a[38:39], v131 offset:1920
    v_mfma_f32_16x16x32_bf16 v[64:67], a[76:79], a[44:47], v[64:67]
    ds_read_b64_tr_b16 a[40:41], v132 offset:192
    v_mfma_f32_16x16x32_bf16 v[68:71], a[76:79], a[48:51], v[68:71]
    ds_read_b64_tr_b16 a[42:43], v132 offset:1984
    v_mfma_f32_16x16x32_bf16 v[72:75], a[76:79], a[52:55], v[72:75]
    v_mfma_f32_16x16x32_bf16 v[76:79], a[76:79], a[56:59], v[76:79]
    v_mfma_f32_16x16x32_bf16 v[80:83], a[80:83], a[44:47], v[80:83]
    v_mfma_f32_16x16x32_bf16 v[84:87], a[80:83], a[48:51], v[84:87]
    v_mfma_f32_16x16x32_bf16 v[88:91], a[80:83], a[52:55], v[88:91]
    v_mfma_f32_16x16x32_bf16 v[92:95], a[80:83], a[56:59], v[92:95]
    v_mfma_f32_16x16x32_bf16 v[96:99], a[84:87], a[44:47], v[96:99]
    v_mfma_f32_16x16x32_bf16 v[100:103], a[84:87], a[48:51], v[100:103]
    v_mfma_f32_16x16x32_bf16 v[104:107], a[84:87], a[52:55], v[104:107]
    v_mfma_f32_16x16x32_bf16 v[108:111], a[84:87], a[56:59], v[108:111]
    s_cmp_lg_u32 s83, 0
    s_cbranch_scc1 L_FLOOP
    s_setprio 1
    s_lshl_b32 s68, s84, 8
    v_lshl_add_u32 v136, v150, 2, s68
    s_waitcnt lgkmcnt(0)
    ds_read_b32 v132, v136 offset:1024
    ds_read_b32 v133, v136 offset:1088
    ds_read_b32 v134, v136 offset:1152
    ds_read_b32 v135, v136 offset:1216
    v_mov_b32 v159, 0
    ds_read_b32 v158, v159 offset:64
    s_lshl_b32 s68, s61, 1
    s_add_u32 s68, s68, s84
    s_mul_i32 s78, s68, 294912
    v_lshlrev_b32 v145, 4, v144
    s_mul_i32 s68, s62, 28672
    s_add_u32 s78, s78, s68
    s_lshl_b32 s68, s85, 14
    s_add_u32 s79, s78, s68
    s_lshl_b32 s68, s85, 10
    s_add_u32 s78, s78, s68
    s_add_u32 s78, s78, 12288
    s_mov_b32 s72, 0xbdd2d3e8
    s_mov_b32 s73, 0xbdd2d3e8
    v_mov_b32 v138, 0xc0135761
    v_mov_b32 v139, 0xc0135761
    s_mov_b32 s70, 0x3fb8aa3b
    s_mov_b32 s71, 0x7149f2ca
    s_waitcnt lgkmcnt(0)
    v_mul_f32 v132, s70, v132
    v_mul_f32 v133, s70, v133
    v_mul_f32 v134, s70, v134
    v_mul_f32 v135, s70, v135
    v_exp_f32 v132, v132
    v_exp_f32 v133, v133
    v_exp_f32 v134, v134
    v_exp_f32 v135, v135
    s_nop 0
    v_add_f32 v132, 1.0, v132
    v_add_f32 v133, 1.0, v133
    v_add_f32 v134, 1.0, v134
    v_add_f32 v135, 1.0, v135
    v_min_f32 v132, s71, v132
    v_min_f32 v133, s71, v133
    v_min_f32 v134, s71, v134
    v_min_f32 v135, s71, v135
    v_pk_mul_f32 v[112:113], v[0:1], v[0:1]
    v_pk_mul_f32 v[114:115], v[2:3], v[2:3]
    v_pk_mul_f32 v[116:117], v[16:17], v[16:17]
    v_pk_mul_f32 v[118:119], v[18:19], v[18:19]
    v_pk_fma_f32 v[112:113], v[112:113], s[72:73], v[138:139]
    v_pk_fma_f32 v[114:115], v[114:115], s[72:73], v[138:139]
    v_pk_fma_f32 v[116:117], v[116:117], s[72:73], v[138:139]
    v_pk_fma_f32 v[118:119], v[118:119], s[72:73], v[138:139]
    v_pk_mul_f32 v[112:113], v[112:113], v[0:1]
    v_pk_mul_f32 v[114:115], v[114:115], v[2:3]
    v_pk_mul_f32 v[116:117], v[116:117], v[16:17]
    v_pk_mul_f32 v[118:119], v[118:119], v[18:19]
    v_exp_f32 v112, v112
    v_exp_f32 v113, v113
    v_exp_f32 v114, v114
    v_exp_f32 v115, v115
    v_exp_f32 v116, v116
    v_exp_f32 v117, v117
    v_exp_f32 v118, v118
    v_exp_f32 v119, v119
    v_pk_fma_f32 v[112:113], v[112:113], v[132:133], v[132:133] op_sel:[0,0,0] op_sel_hi:[1,0,0]
    v_pk_fma_f32 v[114:115], v[114:115], v[132:133], v[132:133] op_sel:[0,0,0] op_sel_hi:[1,0,0]
    v_pk_fma_f32 v[116:117], v[116:117], v[132:133], v[132:133] op_sel:[0,0,0] op_sel_hi:[1,0,0]
    v_pk_fma_f32 v[118:119], v[118:119], v[132:133], v[132:133] op_sel:[0,0,0] op_sel_hi:[1,0,0]
    v_rcp_f32 v112, v112
    v_rcp_f32 v113, v113
    v_rcp_f32 v114, v114
    v_rcp_f32 v115, v115
    v_rcp_f32 v116, v116
    v_rcp_f32 v117, v117
    v_rcp_f32 v118, v118
    v_rcp_f32 v119, v119
    v_pk_mul_f32 v[112:113], v[112:113], v[0:1]
    v_pk_mul_f32 v[114:115], v[114:115], v[2:3]
    v_pk_mul_f32 v[116:117], v[116:117], v[16:17]
    v_pk_mul_f32 v[118:119], v[118:119], v[18:19]
    v_cvt_pk_bf16_f32 v128, v112, v113
    v_cvt_pk_bf16_f32 v129, v114, v115
    v_cvt_pk_bf16_f32 v130, v116, v117
    v_cvt_pk_bf16_f32 v131, v118, v119
    buffer_store_dwordx4 v[128:131], v145, s[44:47], s79 offen offset:0 sc1
    v_pk_mul_f32 v[120:121], v[4:5], v[4:5]
    v_pk_mul_f32 v[122:123], v[6:7], v[6:7]
    v_pk_mul_f32 v[124:125], v[20:21], v[20:21]
    v_pk_mul_f32 v[126:127], v[22:23], v[22:23]
    v_pk_fma_f32 v[120:121], v[120:121], s[72:73], v[138:139]
    v_pk_fma_f32 v[122:123], v[122:123], s[72:73], v[138:139]
    v_pk_fma_f32 v[124:125], v[124:125], s[72:73], v[138:139]
    v_pk_fma_f32 v[126:127], v[126:127], s[72:73], v[138:139]
    v_pk_mul_f32 v[120:121], v[120:121], v[4:5]
    v_pk_mul_f32 v[122:123], v[122:123], v[6:7]
    v_pk_mul_f32 v[124:125], v[124:125], v[20:21]
    v_pk_mul_f32 v[126:127], v[126:127], v[22:23]
    v_exp_f32 v120, v120
    v_exp_f32 v121, v121
    v_exp_f32 v122, v122
    v_exp_f32 v123, v123
    v_exp_f32 v124, v124
    v_exp_f32 v125, v125
    v_exp_f32 v126, v126
    v_exp_f32 v127, v127
    v_pk_fma_f32 v[120:121], v[120:121], v[132:133], v[132:133] op_sel:[0,1,1] op_sel_hi:[1,1,1]
    v_pk_fma_f32 v[122:123], v[122:123], v[132:133], v[132:133] op_sel:[0,1,1] op_sel_hi:[1,1,1]
    v_pk_fma_f32 v[124:125], v[124:125], v[132:133], v[132:133] op_sel:[0,1,1] op_sel_hi:[1,1,1]
    v_pk_fma_f32 v[126:127], v[126:127], v[132:133], v[132:133] op_sel:[0,1,1] op_sel_hi:[1,1,1]
    v_rcp_f32 v120, v120
    v_rcp_f32 v121, v121
    v_rcp_f32 v122, v122
    v_rcp_f32 v123, v123
    v_rcp_f32 v124, v124
    v_rcp_f32 v125, v125
    v_rcp_f32 v126, v126
    v_rcp_f32 v127, v127
    v_pk_mul_f32 v[120:121], v[120:121], v[4:5]
    v_pk_mul_f32 v[122:123], v[122:123], v[6:7]
    v_pk_mul_f32 v[124:125], v[124:125], v[20:21]
    v_pk_mul_f32 v[126:127], v[126:127], v[22:23]
    v_cvt_pk_bf16_f32 v140, v120, v121
    v_cvt_pk_bf16_f32 v141, v122, v123
    v_cvt_pk_bf16_f32 v142, v124, v125
    v_cvt_pk_bf16_f32 v143, v126, v127
    buffer_store_dwordx4 v[140:143], v145, s[44:47], s79 offen offset:1024 sc1
    v_pk_mul_f32 v[112:113], v[8:9], v[8:9]
    v_pk_mul_f32 v[114:115], v[10:11], v[10:11]
    v_pk_mul_f32 v[116:117], v[24:25], v[24:25]
    v_pk_mul_f32 v[118:119], v[26:27], v[26:27]
    v_pk_fma_f32 v[112:113], v[112:113], s[72:73], v[138:139]
    v_pk_fma_f32 v[114:115], v[114:115], s[72:73], v[138:139]
    v_pk_fma_f32 v[116:117], v[116:117], s[72:73], v[138:139]
    v_pk_fma_f32 v[118:119], v[118:119], s[72:73], v[138:139]
    v_pk_mul_f32 v[112:113], v[112:113], v[8:9]
    v_pk_mul_f32 v[114:115], v[114:115], v[10:11]
    v_pk_mul_f32 v[116:117], v[116:117], v[24:25]
    v_pk_mul_f32 v[118:119], v[118:119], v[26:27]
    v_exp_f32 v112, v112
    v_exp_f32 v113, v113
    v_exp_f32 v114, v114
    v_exp_f32 v115, v115
    v_exp_f32 v116, v116
    v_exp_f32 v117, v117
    v_exp_f32 v118, v118
    v_exp_f32 v119, v119
    v_pk_fma_f32 v[112:113], v[112:113], v[134:135], v[134:135] op_sel:[0,0,0] op_sel_hi:[1,0,0]
    v_pk_fma_f32 v[114:115], v[114:115], v[134:135], v[134:135] op_sel:[0,0,0] op_sel_hi:[1,0,0]
    v_pk_fma_f32 v[116:117], v[116:117], v[134:135], v[134:135] op_sel:[0,0,0] op_sel_hi:[1,0,0]
    v_pk_fma_f32 v[118:119], v[118:119], v[134:135], v[134:135] op_sel:[0,0,0] op_sel_hi:[1,0,0]
    v_rcp_f32 v112, v112
    v_rcp_f32 v113, v113
    v_rcp_f32 v114, v114
    v_rcp_f32 v115, v115
    v_rcp_f32 v116, v116
    v_rcp_f32 v117, v117
    v_rcp_f32 v118, v118
    v_rcp_f32 v119, v119
    v_pk_mul_f32 v[112:113], v[112:113], v[8:9]
    v_pk_mul_f32 v[114:115], v[114:115], v[10:11]
    v_pk_mul_f32 v[116:117], v[116:117], v[24:25]
    v_pk_mul_f32 v[118:119], v[118:119], v[26:27]
    v_cvt_pk_bf16_f32 v128, v112, v113
    v_cvt_pk_bf16_f32 v129, v114, v115
    v_cvt_pk_bf16_f32 v130, v116, v117
    v_cvt_pk_bf16_f32 v131, v118, v119
    buffer_store_dwordx4 v[128:131], v145, s[44:47], s79 offen offset:2048 sc1
    v_pk_mul_f32 v[120:121], v[12:13], v[12:13]
    v_pk_mul_f32 v[122:123], v[14:15], v[14:15]
    v_pk_mul_f32 v[124:125], v[28:29], v[28:29]
    v_pk_mul_f32 v[126:127], v[30:31], v[30:31]
    v_pk_fma_f32 v[120:121], v[120:121], s[72:73], v[138:139]
    v_pk_fma_f32 v[122:123], v[122:123], s[72:73], v[138:139]
    v_pk_fma_f32 v[124:125], v[124:125], s[72:73], v[138:139]
    v_pk_fma_f32 v[126:127], v[126:127], s[72:73], v[138:139]
    v_pk_mul_f32 v[120:121], v[120:121], v[12:13]
    v_pk_mul_f32 v[122:123], v[122:123], v[14:15]
    v_pk_mul_f32 v[124:125], v[124:125], v[28:29]
    v_pk_mul_f32 v[126:127], v[126:127], v[30:31]
    v_exp_f32 v120, v120
    v_exp_f32 v121, v121
    v_exp_f32 v122, v122
    v_exp_f32 v123, v123
    v_exp_f32 v124, v124
    v_exp_f32 v125, v125
    v_exp_f32 v126, v126
    v_exp_f32 v127, v127
    v_pk_fma_f32 v[120:121], v[120:121], v[134:135], v[134:135] op_sel:[0,1,1] op_sel_hi:[1,1,1]
    v_pk_fma_f32 v[122:123], v[122:123], v[134:135], v[134:135] op_sel:[0,1,1] op_sel_hi:[1,1,1]
    v_pk_fma_f32 v[124:125], v[124:125], v[134:135], v[134:135] op_sel:[0,1,1] op_sel_hi:[1,1,1]
    v_pk_fma_f32 v[126:127], v[126:127], v[134:135], v[134:135] op_sel:[0,1,1] op_sel_hi:[1,1,1]
    v_rcp_f32 v120, v120
    v_rcp_f32 v121, v121
    v_rcp_f32 v122, v122
    v_rcp_f32 v123, v123
    v_rcp_f32 v124, v124
    v_rcp_f32 v125, v125
    v_rcp_f32 v126, v126
    v_rcp_f32 v127, v127
    v_pk_mul_f32 v[120:121], v[120:121], v[12:13]
    v_pk_mul_f32 v[122:123], v[122:123], v[14:15]
    v_pk_mul_f32 v[124:125], v[124:125], v[28:29]
    v_pk_mul_f32 v[126:127], v[126:127], v[30:31]
    v_cvt_pk_bf16_f32 v140, v120, v121
    v_cvt_pk_bf16_f32 v141, v122, v123
    v_cvt_pk_bf16_f32 v142, v124, v125
    v_cvt_pk_bf16_f32 v143, v126, v127
    buffer_store_dwordx4 v[140:143], v145, s[44:47], s79 offen offset:3072 sc1
    s_add_u32 s79, s79, 4096
    v_pk_mul_f32 v[112:113], v[32:33], v[32:33]
    v_pk_mul_f32 v[114:115], v[34:35], v[34:35]
    v_pk_mul_f32 v[116:117], v[48:49], v[48:49]
    v_pk_mul_f32 v[118:119], v[50:51], v[50:51]
    v_pk_fma_f32 v[112:113], v[112:113], s[72:73], v[138:139]
    v_pk_fma_f32 v[114:115], v[114:115], s[72:73], v[138:139]
    v_pk_fma_f32 v[116:117], v[116:117], s[72:73], v[138:139]
    v_pk_fma_f32 v[118:119], v[118:119], s[72:73], v[138:139]
    v_pk_mul_f32 v[112:113], v[112:113], v[32:33]
    v_pk_mul_f32 v[114:115], v[114:115], v[34:35]
    v_pk_mul_f32 v[116:117], v[116:117], v[48:49]
    v_pk_mul_f32 v[118:119], v[118:119], v[50:51]
    v_exp_f32 v112, v112
    v_exp_f32 v113, v113
    v_exp_f32 v114, v114
    v_exp_f32 v115, v115
    v_exp_f32 v116, v116
    v_exp_f32 v117, v117
    v_exp_f32 v118, v118
    v_exp_f32 v119, v119
    v_pk_fma_f32 v[112:113], v[112:113], v[132:133], v[132:133] op_sel:[0,0,0] op_sel_hi:[1,0,0]
    v_pk_fma_f32 v[114:115], v[114:115], v[132:133], v[132:133] op_sel:[0,0,0] op_sel_hi:[1,0,0]
    v_pk_fma_f32 v[116:117], v[116:117], v[132:133], v[132:133] op_sel:[0,0,0] op_sel_hi:[1,0,0]
    v_pk_fma_f32 v[118:119], v[118:119], v[132:133], v[132:133] op_sel:[0,0,0] op_sel_hi:[1,0,0]
    v_rcp_f32 v112, v112
    v_rcp_f32 v113, v113
    v_rcp_f32 v114, v114
    v_rcp_f32 v115, v115
    v_rcp_f32 v116, v116
    v_rcp_f32 v117, v117
    v_rcp_f32 v118, v118
    v_rcp_f32 v119, v119
    v_pk_mul_f32 v[112:113], v[112:113], v[32:33]
    v_pk_mul_f32 v[114:115], v[114:115], v[34:35]
    v_pk_mul_f32 v[116:117], v[116:117], v[48:49]
    v_pk_mul_f32 v[118:119], v[118:119], v[50:51]
    v_cvt_pk_bf16_f32 v128, v112, v113
    v_cvt_pk_bf16_f32 v129, v114, v115
    v_cvt_pk_bf16_f32 v130, v116, v117
    v_cvt_pk_bf16_f32 v131, v118, v119
    buffer_store_dwordx4 v[128:131], v145, s[44:47], s79 offen offset:0 sc1
    v_pk_mul_f32 v[120:121], v[36:37], v[36:37]
    v_pk_mul_f32 v[122:123], v[38:39], v[38:39]
    v_pk_mul_f32 v[124:125], v[52:53], v[52:53]
    v_pk_mul_f32 v[126:127], v[54:55], v[54:55]
    v_pk_fma_f32 v[120:121], v[120:121], s[72:73], v[138:139]
    v_pk_fma_f32 v[122:123], v[122:123], s[72:73], v[138:139]
    v_pk_fma_f32 v[124:125], v[124:125], s[72:73], v[138:139]
    v_pk_fma_f32 v[126:127], v[126:127], s[72:73], v[138:139]
    v_pk_mul_f32 v[120:121], v[120:121], v[36:37]
    v_pk_mul_f32 v[122:123], v[122:123], v[38:39]
    v_pk_mul_f32 v[124:125], v[124:125], v[52:53]
    v_pk_mul_f32 v[126:127], v[126:127], v[54:55]
    v_exp_f32 v120, v120
    v_exp_f32 v121, v121
    v_exp_f32 v122, v122
    v_exp_f32 v123, v123
    v_exp_f32 v124, v124
    v_exp_f32 v125, v125
    v_exp_f32 v126, v126
    v_exp_f32 v127, v127
    v_pk_fma_f32 v[120:121], v[120:121], v[132:133], v[132:133] op_sel:[0,1,1] op_sel_hi:[1,1,1]
    v_pk_fma_f32 v[122:123], v[122:123], v[132:133], v[132:133] op_sel:[0,1,1] op_sel_hi:[1,1,1]
    v_pk_fma_f32 v[124:125], v[124:125], v[132:133], v[132:133] op_sel:[0,1,1] op_sel_hi:[1,1,1]
    v_pk_fma_f32 v[126:127], v[126:127], v[132:133], v[132:133] op_sel:[0,1,1] op_sel_hi:[1,1,1]
    v_rcp_f32 v120, v120
    v_rcp_f32 v121, v121
    v_rcp_f32 v122, v122
    v_rcp_f32 v123, v123
    v_rcp_f32 v124, v124
    v_rcp_f32 v125, v125
    v_rcp_f32 v126, v126
    v_rcp_f32 v127, v127
    v_pk_mul_f32 v[120:121], v[120:121], v[36:37]
    v_pk_mul_f32 v[122:123], v[122:123], v[38:39]
    v_pk_mul_f32 v[124:125], v[124:125], v[52:53]
    v_pk_mul_f32 v[126:127], v[126:127], v[54:55]
    v_cvt_pk_bf16_f32 v140, v120, v121
    v_cvt_pk_bf16_f32 v141, v122, v123
    v_cvt_pk_bf16_f32 v142, v124, v125
    v_cvt_pk_bf16_f32 v143, v126, v127
    buffer_store_dwordx4 v[140:143], v145, s[44:47], s79 offen offset:1024 sc1
    v_pk_mul_f32 v[112:113], v[40:41], v[40:41]
    v_pk_mul_f32 v[114:115], v[42:43], v[42:43]
    v_pk_mul_f32 v[116:117], v[56:57], v[56:57]
    v_pk_mul_f32 v[118:119], v[58:59], v[58:59]
    v_pk_fma_f32 v[112:113], v[112:113], s[72:73], v[138:139]
    v_pk_fma_f32 v[114:115], v[114:115], s[72:73], v[138:139]
    v_pk_fma_f32 v[116:117], v[116:117], s[72:73], v[138:139]
    v_pk_fma_f32 v[118:119], v[118:119], s[72:73], v[138:139]
    v_pk_mul_f32 v[112:113], v[112:113], v[40:41]
    v_pk_mul_f32 v[114:115], v[114:115], v[42:43]
    v_pk_mul_f32 v[116:117], v[116:117], v[56:57]
    v_pk_mul_f32 v[118:119], v[118:119], v[58:59]
    v_exp_f32 v112, v112
    v_exp_f32 v113, v113
    v_exp_f32 v114, v114
    v_exp_f32 v115, v115
    v_exp_f32 v116, v116
    v_exp_f32 v117, v117
    v_exp_f32 v118, v118
    v_exp_f32 v119, v119
    v_pk_fma_f32 v[112:113], v[112:113], v[134:135], v[134:135] op_sel:[0,0,0] op_sel_hi:[1,0,0]
    v_pk_fma_f32 v[114:115], v[114:115], v[134:135], v[134:135] op_sel:[0,0,0] op_sel_hi:[1,0,0]
    v_pk_fma_f32 v[116:117], v[116:117], v[134:135], v[134:135] op_sel:[0,0,0] op_sel_hi:[1,0,0]
    v_pk_fma_f32 v[118:119], v[118:119], v[134:135], v[134:135] op_sel:[0,0,0] op_sel_hi:[1,0,0]
    v_rcp_f32 v112, v112
    v_rcp_f32 v113, v113
    v_rcp_f32 v114, v114
    v_rcp_f32 v115, v115
    v_rcp_f32 v116, v116
    v_rcp_f32 v117, v117
    v_rcp_f32 v118, v118
    v_rcp_f32 v119, v119
    v_pk_mul_f32 v[112:113], v[112:113], v[40:41]
    v_pk_mul_f32 v[114:115], v[114:115], v[42:43]
    v_pk_mul_f32 v[116:117], v[116:117], v[56:57]
    v_pk_mul_f32 v[118:119], v[118:119], v[58:59]
    v_cvt_pk_bf16_f32 v128, v112, v113
    v_cvt_pk_bf16_f32 v129, v114, v115
    v_cvt_pk_bf16_f32 v130, v116, v117
    v_cvt_pk_bf16_f32 v131, v118, v119
    buffer_store_dwordx4 v[128:131], v145, s[44:47], s79 offen offset:2048 sc1
    v_pk_mul_f32 v[120:121], v[44:45], v[44:45]
    v_pk_mul_f32 v[122:123], v[46:47], v[46:47]
    v_pk_mul_f32 v[124:125], v[60:61], v[60:61]
    v_pk_mul_f32 v[126:127], v[62:63], v[62:63]
    v_pk_fma_f32 v[120:121], v[120:121], s[72:73], v[138:139]
    v_pk_fma_f32 v[122:123], v[122:123], s[72:73], v[138:139]
    v_pk_fma_f32 v[124:125], v[124:125], s[72:73], v[138:139]
    v_pk_fma_f32 v[126:127], v[126:127], s[72:73], v[138:139]
    v_pk_mul_f32 v[120:121], v[120:121], v[44:45]
    v_pk_mul_f32 v[122:123], v[122:123], v[46:47]
    v_pk_mul_f32 v[124:125], v[124:125], v[60:61]
    v_pk_mul_f32 v[126:127], v[126:127], v[62:63]
    v_exp_f32 v120, v120
    v_exp_f32 v121, v121
    v_exp_f32 v122, v122
    v_exp_f32 v123, v123
    v_exp_f32 v124, v124
    v_exp_f32 v125, v125
    v_exp_f32 v126, v126
    v_exp_f32 v127, v127
    v_pk_fma_f32 v[120:121], v[120:121], v[134:135], v[134:135] op_sel:[0,1,1] op_sel_hi:[1,1,1]
    v_pk_fma_f32 v[122:123], v[122:123], v[134:135], v[134:135] op_sel:[0,1,1] op_sel_hi:[1,1,1]
    v_pk_fma_f32 v[124:125], v[124:125], v[134:135], v[134:135] op_sel:[0,1,1] op_sel_hi:[1,1,1]
    v_pk_fma_f32 v[126:127], v[126:127], v[134:135], v[134:135] op_sel:[0,1,1] op_sel_hi:[1,1,1]
    v_rcp_f32 v120, v120
    v_rcp_f32 v121, v121
    v_rcp_f32 v122, v122
    v_rcp_f32 v123, v123
    v_rcp_f32 v124, v124
    v_rcp_f32 v125, v125
    v_rcp_f32 v126, v126
    v_rcp_f32 v127, v127
    v_pk_mul_f32 v[120:121], v[120:121], v[44:45]
    v_pk_mul_f32 v[122:123], v[122:123], v[46:47]
    v_pk_mul_f32 v[124:125], v[124:125], v[60:61]
    v_pk_mul_f32 v[126:127], v[126:127], v[62:63]
    v_cvt_pk_bf16_f32 v140, v120, v121
    v_cvt_pk_bf16_f32 v141, v122, v123
    v_cvt_pk_bf16_f32 v142, v124, v125
    v_cvt_pk_bf16_f32 v143, v126, v127
    buffer_store_dwordx4 v[140:143], v145, s[44:47], s79 offen offset:3072 sc1
    s_add_u32 s79, s79, 4096
    v_pk_mul_f32 v[112:113], v[64:65], v[64:65]
    v_pk_mul_f32 v[114:115], v[66:67], v[66:67]
    v_pk_mul_f32 v[116:117], v[80:81], v[80:81]
    v_pk_mul_f32 v[118:119], v[82:83], v[82:83]
    v_pk_fma_f32 v[112:113], v[112:113], s[72:73], v[138:139]
    v_pk_fma_f32 v[114:115], v[114:115], s[72:73], v[138:139]
    v_pk_fma_f32 v[116:117], v[116:117], s[72:73], v[138:139]
    v_pk_fma_f32 v[118:119], v[118:119], s[72:73], v[138:139]
    v_pk_mul_f32 v[112:113], v[112:113], v[64:65]
    v_pk_mul_f32 v[114:115], v[114:115], v[66:67]
    v_pk_mul_f32 v[116:117], v[116:117], v[80:81]
    v_pk_mul_f32 v[118:119], v[118:119], v[82:83]
    v_exp_f32 v112, v112
    v_exp_f32 v113, v113
    v_exp_f32 v114, v114
    v_exp_f32 v115, v115
    v_exp_f32 v116, v116
    v_exp_f32 v117, v117
    v_exp_f32 v118, v118
    v_exp_f32 v119, v119
    v_pk_fma_f32 v[112:113], v[112:113], v[132:133], v[132:133] op_sel:[0,0,0] op_sel_hi:[1,0,0]
    v_pk_fma_f32 v[114:115], v[114:115], v[132:133], v[132:133] op_sel:[0,0,0] op_sel_hi:[1,0,0]
    v_pk_fma_f32 v[116:117], v[116:117], v[132:133], v[132:133] op_sel:[0,0,0] op_sel_hi:[1,0,0]
    v_pk_fma_f32 v[118:119], v[118:119], v[132:133], v[132:133] op_sel:[0,0,0] op_sel_hi:[1,0,0]
    v_rcp_f32 v112, v112
    v_rcp_f32 v113, v113
    v_rcp_f32 v114, v114
    v_rcp_f32 v115, v115
    v_rcp_f32 v116, v116
    v_rcp_f32 v117, v117
    v_rcp_f32 v118, v118
    v_rcp_f32 v119, v119
    v_pk_mul_f32 v[112:113], v[112:113], v[64:65]
    v_pk_mul_f32 v[114:115], v[114:115], v[66:67]
    v_pk_mul_f32 v[116:117], v[116:117], v[80:81]
    v_pk_mul_f32 v[118:119], v[118:119], v[82:83]
    v_cvt_pk_bf16_f32 v128, v112, v113
    v_cvt_pk_bf16_f32 v129, v114, v115
    v_cvt_pk_bf16_f32 v130, v116, v117
    v_cvt_pk_bf16_f32 v131, v118, v119
    buffer_store_dwordx4 v[128:131], v145, s[44:47], s79 offen offset:0 sc1
    v_pk_mul_f32 v[120:121], v[68:69], v[68:69]
    v_pk_mul_f32 v[122:123], v[70:71], v[70:71]
    v_pk_mul_f32 v[124:125], v[84:85], v[84:85]
    v_pk_mul_f32 v[126:127], v[86:87], v[86:87]
    v_pk_fma_f32 v[120:121], v[120:121], s[72:73], v[138:139]
    v_pk_fma_f32 v[122:123], v[122:123], s[72:73], v[138:139]
    v_pk_fma_f32 v[124:125], v[124:125], s[72:73], v[138:139]
    v_pk_fma_f32 v[126:127], v[126:127], s[72:73], v[138:139]
    v_pk_mul_f32 v[120:121], v[120:121], v[68:69]
    v_pk_mul_f32 v[122:123], v[122:123], v[70:71]
    v_pk_mul_f32 v[124:125], v[124:125], v[84:85]
    v_pk_mul_f32 v[126:127], v[126:127], v[86:87]
    v_exp_f32 v120, v120
    v_exp_f32 v121, v121
    v_exp_f32 v122, v122
    v_exp_f32 v123, v123
    v_exp_f32 v124, v124
    v_exp_f32 v125, v125
    v_exp_f32 v126, v126
    v_exp_f32 v127, v127
    v_pk_fma_f32 v[120:121], v[120:121], v[132:133], v[132:133] op_sel:[0,1,1] op_sel_hi:[1,1,1]
    v_pk_fma_f32 v[122:123], v[122:123], v[132:133], v[132:133] op_sel:[0,1,1] op_sel_hi:[1,1,1]
    v_pk_fma_f32 v[124:125], v[124:125], v[132:133], v[132:133] op_sel:[0,1,1] op_sel_hi:[1,1,1]
    v_pk_fma_f32 v[126:127], v[126:127], v[132:133], v[132:133] op_sel:[0,1,1] op_sel_hi:[1,1,1]
    v_rcp_f32 v120, v120
    v_rcp_f32 v121, v121
    v_rcp_f32 v122, v122
    v_rcp_f32 v123, v123
    v_rcp_f32 v124, v124
    v_rcp_f32 v125, v125
    v_rcp_f32 v126, v126
    v_rcp_f32 v127, v127
    v_pk_mul_f32 v[120:121], v[120:121], v[68:69]
    v_pk_mul_f32 v[122:123], v[122:123], v[70:71]
    v_pk_mul_f32 v[124:125], v[124:125], v[84:85]
    v_pk_mul_f32 v[126:127], v[126:127], v[86:87]
    v_cvt_pk_bf16_f32 v140, v120, v121
    v_cvt_pk_bf16_f32 v141, v122, v123
    v_cvt_pk_bf16_f32 v142, v124, v125
    v_cvt_pk_bf16_f32 v143, v126, v127
    buffer_store_dwordx4 v[140:143], v145, s[44:47], s79 offen offset:1024 sc1
    v_pk_mul_f32 v[112:113], v[72:73], v[72:73]
    v_pk_mul_f32 v[114:115], v[74:75], v[74:75]
    v_pk_mul_f32 v[116:117], v[88:89], v[88:89]
    v_pk_mul_f32 v[118:119], v[90:91], v[90:91]
    v_pk_fma_f32 v[112:113], v[112:113], s[72:73], v[138:139]
    v_pk_fma_f32 v[114:115], v[114:115], s[72:73], v[138:139]
    v_pk_fma_f32 v[116:117], v[116:117], s[72:73], v[138:139]
    v_pk_fma_f32 v[118:119], v[118:119], s[72:73], v[138:139]
    v_pk_mul_f32 v[112:113], v[112:113], v[72:73]
    v_pk_mul_f32 v[114:115], v[114:115], v[74:75]
    v_pk_mul_f32 v[116:117], v[116:117], v[88:89]
    v_pk_mul_f32 v[118:119], v[118:119], v[90:91]
    v_exp_f32 v112, v112
    v_exp_f32 v113, v113
    v_exp_f32 v114, v114
    v_exp_f32 v115, v115
    v_exp_f32 v116, v116
    v_exp_f32 v117, v117
    v_exp_f32 v118, v118
    v_exp_f32 v119, v119
    v_pk_fma_f32 v[112:113], v[112:113], v[134:135], v[134:135] op_sel:[0,0,0] op_sel_hi:[1,0,0]
    v_pk_fma_f32 v[114:115], v[114:115], v[134:135], v[134:135] op_sel:[0,0,0] op_sel_hi:[1,0,0]
    v_pk_fma_f32 v[116:117], v[116:117], v[134:135], v[134:135] op_sel:[0,0,0] op_sel_hi:[1,0,0]
    v_pk_fma_f32 v[118:119], v[118:119], v[134:135], v[134:135] op_sel:[0,0,0] op_sel_hi:[1,0,0]
    v_rcp_f32 v112, v112
    v_rcp_f32 v113, v113
    v_rcp_f32 v114, v114
    v_rcp_f32 v115, v115
    v_rcp_f32 v116, v116
    v_rcp_f32 v117, v117
    v_rcp_f32 v118, v118
    v_rcp_f32 v119, v119
    v_pk_mul_f32 v[112:113], v[112:113], v[72:73]
    v_pk_mul_f32 v[114:115], v[114:115], v[74:75]
    v_pk_mul_f32 v[116:117], v[116:117], v[88:89]
    v_pk_mul_f32 v[118:119], v[118:119], v[90:91]
    v_cvt_pk_bf16_f32 v128, v112, v113
    v_cvt_pk_bf16_f32 v129, v114, v115
    v_cvt_pk_bf16_f32 v130, v116, v117
    v_cvt_pk_bf16_f32 v131, v118, v119
    buffer_store_dwordx4 v[128:131], v145, s[44:47], s79 offen offset:2048 sc1
    v_pk_mul_f32 v[120:121], v[76:77], v[76:77]
    v_pk_mul_f32 v[122:123], v[78:79], v[78:79]
    v_pk_mul_f32 v[124:125], v[92:93], v[92:93]
    v_pk_mul_f32 v[126:127], v[94:95], v[94:95]
    v_pk_fma_f32 v[120:121], v[120:121], s[72:73], v[138:139]
    v_pk_fma_f32 v[122:123], v[122:123], s[72:73], v[138:139]
    v_pk_fma_f32 v[124:125], v[124:125], s[72:73], v[138:139]
    v_pk_fma_f32 v[126:127], v[126:127], s[72:73], v[138:139]
    v_pk_mul_f32 v[120:121], v[120:121], v[76:77]
    v_pk_mul_f32 v[122:123], v[122:123], v[78:79]
    v_pk_mul_f32 v[124:125], v[124:125], v[92:93]
    v_pk_mul_f32 v[126:127], v[126:127], v[94:95]
    v_exp_f32 v120, v120
    v_exp_f32 v121, v121
    v_exp_f32 v122, v122
    v_exp_f32 v123, v123
    v_exp_f32 v124, v124
    v_exp_f32 v125, v125
    v_exp_f32 v126, v126
    v_exp_f32 v127, v127
    v_pk_fma_f32 v[120:121], v[120:121], v[134:135], v[134:135] op_sel:[0,1,1] op_sel_hi:[1,1,1]
    v_pk_fma_f32 v[122:123], v[122:123], v[134:135], v[134:135] op_sel:[0,1,1] op_sel_hi:[1,1,1]
    v_pk_fma_f32 v[124:125], v[124:125], v[134:135], v[134:135] op_sel:[0,1,1] op_sel_hi:[1,1,1]
    v_pk_fma_f32 v[126:127], v[126:127], v[134:135], v[134:135] op_sel:[0,1,1] op_sel_hi:[1,1,1]
    v_rcp_f32 v120, v120
    v_rcp_f32 v121, v121
    v_rcp_f32 v122, v122
    v_rcp_f32 v123, v123
    v_rcp_f32 v124, v124
    v_rcp_f32 v125, v125
    v_rcp_f32 v126, v126
    v_rcp_f32 v127, v127
    v_pk_mul_f32 v[120:121], v[120:121], v[76:77]
    v_pk_mul_f32 v[122:123], v[122:123], v[78:79]
    v_pk_mul_f32 v[124:125], v[124:125], v[92:93]
    v_pk_mul_f32 v[126:127], v[126:127], v[94:95]
    v_cvt_pk_bf16_f32 v140, v120, v121
    v_cvt_pk_bf16_f32 v141, v122, v123
    v_cvt_pk_bf16_f32 v142, v124, v125
    v_cvt_pk_bf16_f32 v143, v126, v127
    buffer_store_dwordx4 v[140:143], v145, s[44:47], s79 offen offset:3072 sc1
    v_pk_mul_f32 v[112:113], v[96:97], v[96:97]
    v_pk_mul_f32 v[114:115], v[98:99], v[98:99]
    v_pk_mul_f32 v[116:117], v[100:101], v[100:101]
    v_pk_mul_f32 v[118:119], v[102:103], v[102:103]
    v_pk_fma_f32 v[112:113], v[112:113], s[72:73], v[138:139]
    v_pk_fma_f32 v[114:115], v[114:115], s[72:73], v[138:139]
    v_pk_fma_f32 v[116:117], v[116:117], s[72:73], v[138:139]
    v_pk_fma_f32 v[118:119], v[118:119], s[72:73], v[138:139]
    v_pk_mul_f32 v[112:113], v[112:113], v[96:97]
    v_pk_mul_f32 v[114:115], v[114:115], v[98:99]
    v_pk_mul_f32 v[116:117], v[116:117], v[100:101]
    v_pk_mul_f32 v[118:119], v[118:119], v[102:103]
    v_exp_f32 v112, v112
    v_exp_f32 v113, v113
    v_exp_f32 v114, v114
    v_exp_f32 v115, v115
    v_exp_f32 v116, v116
    v_exp_f32 v117, v117
    v_exp_f32 v118, v118
    v_exp_f32 v119, v119
    v_pk_fma_f32 v[112:113], v[112:113], v[132:133], v[132:133] op_sel:[0,0,0] op_sel_hi:[1,0,0]
    v_pk_fma_f32 v[114:115], v[114:115], v[132:133], v[132:133] op_sel:[0,0,0] op_sel_hi:[1,0,0]
    v_pk_fma_f32 v[116:117], v[116:117], v[132:133], v[132:133] op_sel:[0,1,1] op_sel_hi:[1,1,1]
    v_pk_fma_f32 v[118:119], v[118:119], v[132:133], v[132:133] op_sel:[0,1,1] op_sel_hi:[1,1,1]
    v_rcp_f32 v112, v112
    v_rcp_f32 v113, v113
    v_rcp_f32 v114, v114
    v_rcp_f32 v115, v115
    v_rcp_f32 v116, v116
    v_rcp_f32 v117, v117
    v_rcp_f32 v118, v118
    v_rcp_f32 v119, v119
    v_pk_mul_f32 v[112:113], v[112:113], v[96:97]
    v_pk_mul_f32 v[114:115], v[114:115], v[98:99]
    v_pk_mul_f32 v[116:117], v[116:117], v[100:101]
    v_pk_mul_f32 v[118:119], v[118:119], v[102:103]
    v_cvt_pk_bf16_f32 v128, v112, v113
    v_cvt_pk_bf16_f32 v129, v114, v115
    v_cvt_pk_bf16_f32 v130, v116, v117
    v_cvt_pk_bf16_f32 v131, v118, v119
    buffer_store_dwordx4 v[128:131], v145, s[44:47], s78 offen offset:0 sc1
    v_pk_mul_f32 v[120:121], v[104:105], v[104:105]
    v_pk_mul_f32 v[122:123], v[106:107], v[106:107]
    v_pk_mul_f32 v[124:125], v[108:109], v[108:109]
    v_pk_mul_f32 v[126:127], v[110:111], v[110:111]
    v_pk_fma_f32 v[120:121], v[120:121], s[72:73], v[138:139]
    v_pk_fma_f32 v[122:123], v[122:123], s[72:73], v[138:139]
    v_pk_fma_f32 v[124:125], v[124:125], s[72:73], v[138:139]
    v_pk_fma_f32 v[126:127], v[126:127], s[72:73], v[138:139]
    v_pk_mul_f32 v[120:121], v[120:121], v[104:105]
    v_pk_mul_f32 v[122:123], v[122:123], v[106:107]
    v_pk_mul_f32 v[124:125], v[124:125], v[108:109]
    v_pk_mul_f32 v[126:127], v[126:127], v[110:111]
    v_exp_f32 v120, v120
    v_exp_f32 v121, v121
    v_exp_f32 v122, v122
    v_exp_f32 v123, v123
    v_exp_f32 v124, v124
    v_exp_f32 v125, v125
    v_exp_f32 v126, v126
    v_exp_f32 v127, v127
    v_pk_fma_f32 v[120:121], v[120:121], v[134:135], v[134:135] op_sel:[0,0,0] op_sel_hi:[1,0,0]
    v_pk_fma_f32 v[122:123], v[122:123], v[134:135], v[134:135] op_sel:[0,0,0] op_sel_hi:[1,0,0]
    v_pk_fma_f32 v[124:125], v[124:125], v[134:135], v[134:135] op_sel:[0,1,1] op_sel_hi:[1,1,1]
    v_pk_fma_f32 v[126:127], v[126:127], v[134:135], v[134:135] op_sel:[0,1,1] op_sel_hi:[1,1,1]
    v_rcp_f32 v120, v120
    v_rcp_f32 v121, v121
    v_rcp_f32 v122, v122
    v_rcp_f32 v123, v123
    v_rcp_f32 v124, v124
    v_rcp_f32 v125, v125
    v_rcp_f32 v126, v126
    v_rcp_f32 v127, v127
    v_pk_mul_f32 v[120:121], v[120:121], v[104:105]
    v_pk_mul_f32 v[122:123], v[122:123], v[106:107]
    v_pk_mul_f32 v[124:125], v[124:125], v[108:109]
    v_pk_mul_f32 v[126:127], v[126:127], v[110:111]
    v_cvt_pk_bf16_f32 v140, v120, v121
    v_cvt_pk_bf16_f32 v141, v122, v123
    v_cvt_pk_bf16_f32 v142, v124, v125
    v_cvt_pk_bf16_f32 v143, v126, v127
    buffer_store_dwordx4 v[140:143], v145, s[44:47], s78 offen offset:2048 sc1
    s_branch L_CDONE
L_C_ATT:
    v_lshrrev_b32 v155, 1, v151
    v_mul_u32_u24 v155, 6144, v155
    v_and_b32 v156, 1, v151
    v_lshl_add_u32 v155, v156, 10, v155
    v_lshl_add_u32 v155, v152, 7, v155
    v_lshl_add_u32 v155, v153, 3, v155
    v_add_u32 v155, 92160, v155
    v_lshrrev_b32 v157, 1, v152
    v_lshl_or_b32 v157, v156, 1, v157
    s_lshl_b32 s68, s85, 1
    v_xor_b32 v157, s68, v157
    v_lshl_add_u32 v130, v157, 5, v155
    v_xor_b32 v131, 32, v130
    v_add_u32 v155, 128, v150
    v_lshrrev_b32 v156, 3, v150
    v_lshl_add_u32 v156, v156, 3, v150
    v_add_u32 v156, 40, v156
    s_cmp_eq_u32 s84, 1
    s_cselect_b64 vcc, -1, 0
    v_cndmask_b32 v155, v155, v156, vcc
    v_bfe_u32 v156, v155, 1, 3
    v_bfe_u32 v157, v155, 4, 1
    v_lshlrev_b32 v157, 2, v157
    v_xor_b32 v156, v156, v157
    v_xor_b32 v156, v156, v151
    v_lshlrev_b32 v155, 7, v155
    v_lshl_add_u32 v155, v156, 4, v155
    v_add_u32 v132, 73728, v155
    v_xor_b32 v133, 64, v132
    v_mov_b32 v155, 0xf149f2ca
    v_lshlrev_b32 v156, 2, v151
    v_sub_u32 v156, v150, v156
    s_or_b32 s68, s61, s84
    s_cmp_lg_u32 s68, 0
    s_cselect_b64 s[70:71], -1, 0
    v_subrev_u32 v157, 0, v156
    v_cmp_gt_u32 vcc, 8, v157
    s_nop 1
    v_cndmask_b32 v112, v155, 0, vcc
    v_cmp_ge_i32 vcc, -9, v157
    s_nop 1
    v_cndmask_b32 v116, v155, 0, vcc
    s_and_b64 vcc, vcc, s[70:71]
    v_cndmask_b32 v120, v155, 0, vcc
    v_cmp_ge_i32 vcc, -1, v157
    s_and_b64 vcc, vcc, s[70:71]
    s_mov_b32 vcc_hi, 0
    v_cndmask_b32 v124, v155, 0, vcc
    v_subrev_u32 v157, 1, v156
    v_cmp_gt_u32 vcc, 8, v157
    s_nop 1
    v_cndmask_b32 v113, v155, 0, vcc
    v_cmp_ge_i32 vcc, -9, v157
    s_nop 1
    v_cndmask_b32 v117, v155, 0, vcc
    s_and_b64 vcc, vcc, s[70:71]
    v_cndmask_b32 v121, v155, 0, vcc
    v_cmp_ge_i32 vcc, -1, v157
    s_and_b64 vcc, vcc, s[70:71]
    s_mov_b32 vcc_hi, 0
    v_cndmask_b32 v125, v155, 0, vcc
    v_subrev_u32 v157, 2, v156
    v_cmp_gt_u32 vcc, 8, v157
    s_nop 1
    v_cndmask_b32 v114, v155, 0, vcc
    v_cmp_ge_i32 vcc, -9, v157
    s_nop 1
    v_cndmask_b32 v118, v155, 0, vcc
    s_and_b64 vcc, vcc, s[70:71]
    v_cndmask_b32 v122, v155, 0, vcc
    v_cmp_ge_i32 vcc, -1, v157
    s_and_b64 vcc, vcc, s[70:71]
    s_mov_b32 vcc_hi, 0
    v_cndmask_b32 v126, v155, 0, vcc
    v_subrev_u32 v157, 3, v156
    v_cmp_gt_u32 vcc, 8, v157
    s_nop 1
    v_cndmask_b32 v115, v155, 0, vcc
    v_cmp_ge_i32 vcc, -9, v157
    s_nop 1
    v_cndmask_b32 v119, v155, 0, vcc
    s_and_b64 vcc, vcc, s[70:71]
    v_cndmask_b32 v123, v155, 0, vcc
    v_cmp_ge_i32 vcc, -1, v157
    s_and_b64 vcc, vcc, s[70:71]
    s_mov_b32 vcc_hi, 0
    v_cndmask_b32 v127, v155, 0, vcc
    v_mov_b32 v0, 0
    v_mov_b32 v1, 0
    v_mov_b32 v2, 0
    v_mov_b32 v3, 0
    v_mov_b32 v4, 0
    v_mov_b32 v5, 0
    v_mov_b32 v6, 0
    v_mov_b32 v7, 0
    v_mov_b32 v8, 0
    v_mov_b32 v9, 0
    v_mov_b32 v10, 0
    v_mov_b32 v11, 0
    v_mov_b32 v12, 0
    v_mov_b32 v13, 0
    v_mov_b32 v14, 0
    v_mov_b32 v15, 0
    v_mov_b32 v16, 0
    v_mov_b32 v17, 0
    v_mov_b32 v18, 0
    v_mov_b32 v19, 0
    v_mov_b32 v20, 0
    v_mov_b32 v21, 0
    v_mov_b32 v22, 0
    v_mov_b32 v23, 0
    v_mov_b32 v24, 0
    v_mov_b32 v25, 0
    v_mov_b32 v26, 0
    v_mov_b32 v27, 0
    v_mov_b32 v28, 0
    v_mov_b32 v29, 0
    v_mov_b32 v30, 0
    v_mov_b32 v31, 0
    v_mov_b32 v32, 0
    v_mov_b32 v33, 0
    v_mov_b32 v34, 0
    v_mov_b32 v35, 0
    v_mov_b32 v36, 0
    v_mov_b32 v37, 0
    v_mov_b32 v38, 0
    v_mov_b32 v39, 0
    v_mov_b32 v40, 0
    v_mov_b32 v41, 0
    v_mov_b32 v42, 0
    v_mov_b32 v43, 0
    v_mov_b32 v44, 0
    v_mov_b32 v45, 0
    v_mov_b32 v46, 0
    v_mov_b32 v47, 0
    v_mov_b32 v48, 0
    v_mov_b32 v49, 0
    v_mov_b32 v50, 0
    v_mov_b32 v51, 0
    v_mov_b32 v52, 0
    v_mov_b32 v53, 0
    v_mov_b32 v54, 0
    v_mov_b32 v55, 0
    v_mov_b32 v56, 0
    v_mov_b32 v57, 0
    v_mov_b32 v58, 0
    v_mov_b32 v59, 0
    v_mov_b32 v60, 0
    v_mov_b32 v61, 0
    v_mov_b32 v62, 0
    v_mov_b32 v63, 0
    v_mov_b32 v64, 0
    v_mov_b32 v65, 0
    v_mov_b32 v66, 0
    v_mov_b32 v67, 0
    v_mov_b32 v68, 0
    v_mov_b32 v69, 0
    v_mov_b32 v70, 0
    v_mov_b32 v71, 0
    v_mov_b32 v72, 0
    v_mov_b32 v73, 0
    v_mov_b32 v74, 0
    v_mov_b32 v75, 0
    v_mov_b32 v76, 0
    v_mov_b32 v77, 0
    v_mov_b32 v78, 0
    v_mov_b32 v79, 0
    v_mov_b32 v80, 0
    v_mov_b32 v81, 0
    v_mov_b32 v82, 0
    v_mov_b32 v83, 0
    v_mov_b32 v84, 0
    v_mov_b32 v85, 0
    v_mov_b32 v86, 0
    v_mov_b32 v87, 0
    v_mov_b32 v88, 0
    v_mov_b32 v89, 0
    v_mov_b32 v90, 0
    v_mov_b32 v91, 0
    v_mov_b32 v92, 0
    v_mov_b32 v93, 0
    v_mov_b32 v94, 0
    v_mov_b32 v95, 0
    v_mov_b32 v96, 0
    v_mov_b32 v97, 0
    v_mov_b32 v98, 0
    v_mov_b32 v99, 0
    v_mov_b32 v100, 0
    v_mov_b32 v101, 0
    v_mov_b32 v102, 0
    v_mov_b32 v103, 0
    v_mov_b32 v104, 0
    v_mov_b32 v105, 0
    v_mov_b32 v106, 0
    v_mov_b32 v107, 0
    v_mov_b32 v108, 0
    v_mov_b32 v109, 0
    v_mov_b32 v110, 0
    v_mov_b32 v111, 0
    s_waitcnt lgkmcnt(0)
    s_setprio 0
    s_barrier
    ds_read_b128 a[0:3], v128 offset:0
    ds_read_b128 a[4:7], v129 offset:2048
    ds_read_b128 a[8:11], v128 offset:4096
    ds_read_b128 a[12:15], v129 offset:6144
    ds_read_b128 a[16:19], v132
    ds_read_b64_tr_b16 a[20:21], v130 offset:0
    ds_read_b64_tr_b16 a[22:23], v130 offset:512
    ds_read_b64_tr_b16 a[24:25], v131 offset:0
    ds_read_b64_tr_b16 a[26:27], v131 offset:512
    ds_read_b64_tr_b16 a[28:29], v130 offset:2048
    ds_read_b64_tr_b16 a[30:31], v130 offset:2560
    ds_read_b64_tr_b16 a[32:33], v131 offset:2048
    ds_read_b64_tr_b16 a[34:35], v131 offset:2560
    ds_read_b64_tr_b16 a[36:37], v130 offset:4096
    ds_read_b64_tr_b16 a[38:39], v130 offset:4608
    ds_read_b64_tr_b16 a[40:41], v131 offset:4096
    ds_read_b64_tr_b16 a[42:43], v131 offset:4608
    s_mov_b32 s83, 8
L_ALOOP:
    s_waitcnt lgkmcnt(0)
    v_mfma_f32_16x16x32_bf16 v[0:3], a[20:23], a[0:3], v[0:3]
    ds_read_b128 a[44:47], v129 offset:0
    v_mfma_f32_16x16x32_bf16 v[4:7], a[20:23], a[4:7], v[4:7]
    ds_read_b128 a[48:51], v128 offset:2048
    v_mfma_f32_16x16x32_bf16 v[8:11], a[20:23], a[8:11], v[8:11]
    ds_read_b128 a[52:55], v129 offset:4096
    v_mfma_f32_16x16x32_bf16 v[12:15], a[20:23], a[12:15], v[12:15]
    ds_read_b128 a[56:59], v128 offset:6144
    v_mfma_f32_16x16x32_bf16 v[16:19], a[24:27], a[0:3], v[16:19]
    ds_read_b128 a[60:63], v133
    v_mfma_f32_16x16x32_bf16 v[20:23], a[24:27], a[4:7], v[20:23]
    ds_read_b64_tr_b16 a[64:65], v130 offset:12288
    v_mfma_f32_16x16x32_bf16 v[24:27], a[24:27], a[8:11], v[24:27]
    ds_read_b64_tr_b16 a[66:67], v130 offset:12800
    v_mfma_f32_16x16x32_bf16 v[28:31], a[24:27], a[12:15], v[28:31]
    ds_read_b64_tr_b16 a[68:69], v131 offset:12288
    v_mfma_f32_16x16x32_bf16 v[32:35], a[28:31], a[0:3], v[32:35]
    ds_read_b64_tr_b16 a[70:71], v131 offset:12800
    v_mfma_f32_16x16x32_bf16 v[36:39], a[28:31], a[4:7], v[36:39]
    ds_read_b64_tr_b16 a[72:73], v130 offset:14336
    v_mfma_f32_16x16x32_bf16 v[40:43], a[28:31], a[8:11], v[40:43]
    ds_read_b64_tr_b16 a[74:75], v130 offset:14848
    v_mfma_f32_16x16x32_bf16 v[44:47], a[28:31], a[12:15], v[44:47]
    ds_read_b64_tr_b16 a[76:77], v131 offset:14336
    v_mfma_f32_16x16x32_bf16 v[48:51], a[28:31], a[16:19], v[48:51]
    ds_read_b64_tr_b16 a[78:79], v131 offset:14848
    v_mfma_f32_16x16x32_bf16 v[52:55], a[32:35], a[0:3], v[52:55]
    ds_read_b64_tr_b16 a[80:81], v130 offset:16384
    v_mfma_f32_16x16x32_bf16 v[56:59], a[32:35], a[4:7], v[56:59]
    ds_read_b64_tr_b16 a[82:83], v130 offset:16896
    v_mfma_f32_16x16x32_bf16 v[60:63], a[32:35], a[8:11], v[60:63]
    ds_read_b64_tr_b16 a[84:85], v131 offset:16384
    v_mfma_f32_16x16x32_bf16 v[64:67], a[32:35], a[12:15], v[64:67]
    ds_read_b64_tr_b16 a[86:87], v131 offset:16896
    v_mfma_f32_16x16x32_bf16 v[68:71], a[32:35], a[16:19], v[68:71]
    v_mfma_f32_16x16x32_bf16 v[84:87], a[0:3], a[36:39], v[84:87]
    v_mfma_f32_16x16x32_bf16 v[76:79], a[4:7], a[36:39], v[76:79]
    v_mfma_f32_16x16x32_bf16 v[88:91], a[8:11], a[36:39], v[88:91]
    s_add_u32 s72, s74, 45056
    s_cmp_gt_u32 s72, 118784
    s_cselect_b32 s72, 28672, s72
    s_sub_u32 s73, s72, s74
    s_mov_b32 s74, s72
    s_sub_u32 s83, s83, 1
    v_mfma_f32_16x16x32_bf16 v[72:75], a[12:15], a[36:39], v[72:75]
    v_add_u32 v128, s73, v128
    v_mfma_f32_16x16x32_bf16 v[80:83], a[16:19], a[36:39], v[80:83]
    v_add_u32 v129, s73, v129
    v_mfma_f32_16x16x32_bf16 v[104:107], a[0:3], a[40:43], v[104:107]
    v_add_u32 v130, s73, v130
    v_mfma_f32_16x16x32_bf16 v[96:99], a[4:7], a[40:43], v[96:99]
    v_add_u32 v131, s73, v131
    v_mfma_f32_16x16x32_bf16 v[108:111], a[8:11], a[40:43], v[108:111]
    v_add_u32 v132, s73, v132
    v_mfma_f32_16x16x32_bf16 v[92:95], a[12:15], a[40:43], v[92:95]
    v_add_u32 v133, s73, v133
    v_mfma_f32_16x16x32_bf16 v[100:103], a[16:19], a[40:43], v[100:103]
    s_waitcnt lgkmcnt(0)
    s_cmp_le_u32 s83, 1
    s_cbranch_scc1 L_ALOOP_SIG
    s_barrier
L_ALOOP_BACK:
    v_mfma_f32_16x16x32_bf16 v[0:3], a[64:67], a[44:47], v[0:3]
    ds_read_b128 a[0:3], v128 offset:0
    v_mfma_f32_16x16x32_bf16 v[4:7], a[64:67], a[48:51], v[4:7]
    ds_read_b128 a[4:7], v129 offset:2048
    v_mfma_f32_16x16x32_bf16 v[8:11], a[64:67], a[52:55], v[8:11]
    ds_read_b128 a[8:11], v128 offset:4096
    v_mfma_f32_16x16x32_bf16 v[12:15], a[64:67], a[56:59], v[12:15]
    ds_read_b128 a[12:15], v129 offset:6144
    v_mfma_f32_16x16x32_bf16 v[16:19], a[68:71], a[44:47], v[16:19]
    ds_read_b128 a[16:19], v132
    v_mfma_f32_16x16x32_bf16 v[20:23], a[68:71], a[48:51], v[20:23]
    ds_read_b64_tr_b16 a[20:21], v130 offset:0
    v_mfma_f32_16x16x32_bf16 v[24:27], a[68:71], a[52:55], v[24:27]
    ds_read_b64_tr_b16 a[22:23], v130 offset:512
    v_mfma_f32_16x16x32_bf16 v[28:31], a[68:71], a[56:59], v[28:31]
    ds_read_b64_tr_b16 a[24:25], v131 offset:0
    v_mfma_f32_16x16x32_bf16 v[32:35], a[72:75], a[44:47], v[32:35]
    ds_read_b64_tr_b16 a[26:27], v131 offset:512
    v_mfma_f32_16x16x32_bf16 v[36:39], a[72:75], a[48:51], v[36:39]
    ds_read_b64_tr_b16 a[28:29], v130 offset:2048
    v_mfma_f32_16x16x32_bf16 v[40:43], a[72:75], a[52:55], v[40:43]
    ds_read_b64_tr_b16 a[30:31], v130 offset:2560
    v_mfma_f32_16x16x32_bf16 v[44:47], a[72:75], a[56:59], v[44:47]
    ds_read_b64_tr_b16 a[32:33], v131 offset:2048
    v_mfma_f32_16x16x32_bf16 v[48:51], a[72:75], a[60:63], v[48:51]
    ds_read_b64_tr_b16 a[34:35], v131 offset:2560
    v_mfma_f32_16x16x32_bf16 v[52:55], a[76:79], a[44:47], v[52:55]
    ds_read_b64_tr_b16 a[36:37], v130 offset:4096
    v_mfma_f32_16x16x32_bf16 v[56:59], a[76:79], a[48:51], v[56:59]
    ds_read_b64_tr_b16 a[38:39], v130 offset:4608
    v_mfma_f32_16x16x32_bf16 v[60:63], a[76:79], a[52:55], v[60:63]
    ds_read_b64_tr_b16 a[40:41], v131 offset:4096
    v_mfma_f32_16x16x32_bf16 v[64:67], a[76:79], a[56:59], v[64:67]
    ds_read_b64_tr_b16 a[42:43], v131 offset:4608
    v_mfma_f32_16x16x32_bf16 v[68:71], a[76:79], a[60:63], v[68:71]
    v_mfma_f32_16x16x32_bf16 v[84:87], a[44:47], a[80:83], v[84:87]
    v_mfma_f32_16x16x32_bf16 v[76:79], a[48:51], a[80:83], v[76:79]
    v_mfma_f32_16x16x32_bf16 v[88:91], a[52:55], a[80:83], v[88:91]
    v_mfma_f32_16x16x32_bf16 v[72:75], a[56:59], a[80:83], v[72:75]
    v_mfma_f32_16x16x32_bf16 v[80:83], a[60:63], a[80:83], v[80:83]
    v_mfma_f32_16x16x32_bf16 v[104:107], a[44:47], a[84:87], v[104:107]
    v_mfma_f32_16x16x32_bf16 v[96:99], a[48:51], a[84:87], v[96:99]
    v_mfma_f32_16x16x32_bf16 v[108:111], a[52:55], a[84:87], v[108:111]
    v_mfma_f32_16x16x32_bf16 v[92:95], a[56:59], a[84:87], v[92:95]
    v_mfma_f32_16x16x32_bf16 v[100:103], a[60:63], a[84:87], v[100:103]
    s_cmp_lg_u32 s83, 0
    s_cbranch_scc1 L_ALOOP
    s_setprio 1
    s_lshl_b32 s68, s84, 8
    v_lshl_add_u32 v136, v150, 2, s68
    s_waitcnt lgkmcnt(0)
    ds_read_b32 v132, v136 offset:1024
    ds_read_b32 v133, v136 offset:1088
    ds_read_b32 v134, v136 offset:1152
    ds_read_b32 v135, v136 offset:1216
    v_mov_b32 v159, 0
    ds_read_b32 v158, v159 offset:64
    s_lshl_b32 s68, s61, 1
    s_add_u32 s68, s68, s84
    s_mul_i32 s78, s68, 294912
    v_lshlrev_b32 v145, 4, v144
    s_lshl_b32 s68, s62, 1
    s_add_u32 s68, s68, s85
    s_add_u32 s68, s68, 56
    s_lshl_b32 s68, s68, 12
    s_add_u32 s78, s78, s68
    s_mov_b32 s70, 0xbfb8aa3b
    s_mov_b32 s72, 0x3eb8aa3b
    s_mov_b32 s73, 0x3eb8aa3b
    v_cvt_pk_bf16_f32 v0, v0, v1
    v_cvt_pk_bf16_f32 v1, v2, v3
    v_cvt_pk_bf16_f32 v2, v4, v5
    v_cvt_pk_bf16_f32 v3, v6, v7
    v_cvt_pk_bf16_f32 v4, v8, v9
    v_cvt_pk_bf16_f32 v5, v10, v11
    v_cvt_pk_bf16_f32 v6, v12, v13
    v_cvt_pk_bf16_f32 v7, v14, v15
    v_cvt_pk_bf16_f32 v8, v16, v17
    v_cvt_pk_bf16_f32 v9, v18, v19
    v_cvt_pk_bf16_f32 v10, v20, v21
    v_cvt_pk_bf16_f32 v11, v22, v23
    v_cvt_pk_bf16_f32 v12, v24, v25
    v_cvt_pk_bf16_f32 v13, v26, v27
    v_cvt_pk_bf16_f32 v14, v28, v29
    v_cvt_pk_bf16_f32 v15, v30, v31
    v_cvt_pk_bf16_f32 v32, v32, v33
    v_cvt_pk_bf16_f32 v33, v34, v35
    v_cvt_pk_bf16_f32 v34, v36, v37
    v_cvt_pk_bf16_f32 v35, v38, v39
    v_cvt_pk_bf16_f32 v36, v40, v41
    v_cvt_pk_bf16_f32 v37, v42, v43
    v_cvt_pk_bf16_f32 v38, v44, v45
    v_cvt_pk_bf16_f32 v39, v46, v47
    v_cvt_pk_bf16_f32 v40, v48, v49
    v_cvt_pk_bf16_f32 v41, v50, v51
    v_cvt_pk_bf16_f32 v52, v52, v53
    v_cvt_pk_bf16_f32 v53, v54, v55
    v_cvt_pk_bf16_f32 v54, v56, v57
    v_cvt_pk_bf16_f32 v55, v58, v59
    v_cvt_pk_bf16_f32 v56, v60, v61
    v_cvt_pk_bf16_f32 v57, v62, v63
    v_cvt_pk_bf16_f32 v58, v64, v65
    v_cvt_pk_bf16_f32 v59, v66, v67
    v_cvt_pk_bf16_f32 v60, v68, v69
    v_cvt_pk_bf16_f32 v61, v70, v71
    v_cvt_pk_bf16_f32 v72, v72, v73
    v_cvt_pk_bf16_f32 v73, v74, v75
    v_cvt_pk_bf16_f32 v74, v76, v77
    v_cvt_pk_bf16_f32 v75, v78, v79
    v_cvt_pk_bf16_f32 v76, v80, v81
    v_cvt_pk_bf16_f32 v77, v82, v83
    v_cvt_pk_bf16_f32 v78, v84, v85
    v_cvt_pk_bf16_f32 v79, v86, v87
    v_cvt_pk_bf16_f32 v80, v88, v89
    v_cvt_pk_bf16_f32 v81, v90, v91
    v_cvt_pk_bf16_f32 v92, v92, v93
    v_cvt_pk_bf16_f32 v93, v94, v95
    v_cvt_pk_bf16_f32 v94, v96, v97
    v_cvt_pk_bf16_f32 v95, v98, v99
    v_cvt_pk_bf16_f32 v96, v100, v101
    v_cvt_pk_bf16_f32 v97, v102, v103
    v_cvt_pk_bf16_f32 v98, v104, v105
    v_cvt_pk_bf16_f32 v99, v106, v107
    v_cvt_pk_bf16_f32 v100, v108, v109
    v_cvt_pk_bf16_f32 v101, v110, v111
    s_waitcnt lgkmcnt(0)
    v_mul_f32 v132, s70, v132
    v_mul_f32 v133, s70, v133
    v_mul_f32 v134, s70, v134
    v_mul_f32 v135, s70, v135
    v_exp_f32 v132, v132
    v_exp_f32 v133, v133
    v_exp_f32 v134, v134
    v_exp_f32 v135, v135
    v_mov_b32 v128, 0x3f803f80
    v_mov_b32 v129, 0x3f803f80
    v_mov_b32 v130, 0x3f803f80
    v_mov_b32 v131, 0x3f803f80
    v_add_f32 v132, 1.0, v132
    v_add_f32 v133, 1.0, v133
    v_add_f32 v134, 1.0, v134
    v_add_f32 v135, 1.0, v135
    v_mfma_f32_16x16x16_bf16 v[20:23], v[32:33], v[0:1], v[112:115]
    v_mfma_f32_16x16x16_bf16 v[16:19], v[40:41], v[0:1], v[124:127]
    v_mfma_f32_16x16x16_bf16 v[24:27], v[34:35], v[2:3], v[112:115]
    v_mfma_f32_16x16x16_bf16 v[28:31], v[40:41], v[2:3], v[120:123]
    v_mfma_f32_16x16x16_bf16 v[46:49], v[36:37], v[4:5], v[112:115]
    v_mfma_f32_16x16x16_bf16 v[42:45], v[32:33], v[4:5], v[116:119]
    v_mfma_f32_16x16x16_bf16 v[62:65], v[38:39], v[6:7], v[112:115]
    v_mfma_f32_16x16x16_bf16 v[66:69], v[34:35], v[6:7], v[116:119]
    s_nop 7
    v_max3_f32 v50, v16, v17, v18
    v_max3_f32 v51, v19, v20, v21
    v_max3_f32 v70, v24, v25, v26
    v_max3_f32 v71, v27, v28, v29
    v_max3_f32 v82, v42, v43, v44
    v_max3_f32 v83, v45, v46, v47
    v_max3_f32 v102, v62, v63, v64
    v_max3_f32 v103, v65, v66, v67
    v_max3_f32 v50, v50, v22, v23
    v_max3_f32 v70, v70, v30, v31
    v_max3_f32 v82, v82, v48, v49
    v_max3_f32 v102, v102, v68, v69
    v_max_f32 v50, v50, v51
    v_max_f32 v70, v70, v71
    v_max_f32 v82, v82, v83
    v_max_f32 v102, v102, v103
    v_mov_b32 v51, v50
    v_mov_b32 v71, v70
    v_mov_b32 v83, v82
    v_mov_b32 v103, v102
    s_nop 1
    v_permlane16_swap_b32 v51, v50
    v_permlane16_swap_b32 v71, v70
    v_permlane16_swap_b32 v83, v82
    v_permlane16_swap_b32 v103, v102
    s_nop 1
    v_max_f32 v50, v50, v51
    v_max_f32 v70, v70, v71
    v_max_f32 v82, v82, v83
    v_max_f32 v102, v102, v103
    v_mov_b32 v51, v50
    v_mov_b32 v71, v70
    v_mov_b32 v83, v82
    v_mov_b32 v103, v102
    s_nop 1
    v_permlane32_swap_b32 v51, v50
    v_permlane32_swap_b32 v71, v70
    v_permlane32_swap_b32 v83, v82
    v_permlane32_swap_b32 v103, v102
    s_nop 1
    v_max_f32 v50, v50, v51
    v_max_f32 v70, v70, v71
    v_max_f32 v82, v82, v83
    v_max_f32 v102, v102, v103
    v_mul_f32 v50, s72, v50
    v_mul_f32 v70, s72, v70
    v_mul_f32 v82, s72, v82
    v_mul_f32 v102, s72, v102
    v_pk_fma_f32 v[16:17], v[16:17], s[72:73], v[50:51] op_sel_hi:[1,1,0] neg_lo:[0,0,1] neg_hi:[0,0,1]
    v_pk_fma_f32 v[18:19], v[18:19], s[72:73], v[50:51] op_sel_hi:[1,1,0] neg_lo:[0,0,1] neg_hi:[0,0,1]
    v_pk_fma_f32 v[20:21], v[20:21], s[72:73], v[50:51] op_sel_hi:[1,1,0] neg_lo:[0,0,1] neg_hi:[0,0,1]
    v_pk_fma_f32 v[22:23], v[22:23], s[72:73], v[50:51] op_sel_hi:[1,1,0] neg_lo:[0,0,1] neg_hi:[0,0,1]
    v_pk_fma_f32 v[24:25], v[24:25], s[72:73], v[70:71] op_sel_hi:[1,1,0] neg_lo:[0,0,1] neg_hi:[0,0,1]
    v_pk_fma_f32 v[26:27], v[26:27], s[72:73], v[70:71] op_sel_hi:[1,1,0] neg_lo:[0,0,1] neg_hi:[0,0,1]
    v_pk_fma_f32 v[28:29], v[28:29], s[72:73], v[70:71] op_sel_hi:[1,1,0] neg_lo:[0,0,1] neg_hi:[0,0,1]
    v_pk_fma_f32 v[30:31], v[30:31], s[72:73], v[70:71] op_sel_hi:[1,1,0] neg_lo:[0,0,1] neg_hi:[0,0,1]
    v_pk_fma_f32 v[42:43], v[42:43], s[72:73], v[82:83] op_sel_hi:[1,1,0] neg_lo:[0,0,1] neg_hi:[0,0,1]
    v_pk_fma_f32 v[44:45], v[44:45], s[72:73], v[82:83] op_sel_hi:[1,1,0] neg_lo:[0,0,1] neg_hi:[0,0,1]
    v_pk_fma_f32 v[46:47], v[46:47], s[72:73], v[82:83] op_sel_hi:[1,1,0] neg_lo:[0,0,1] neg_hi:[0,0,1]
    v_pk_fma_f32 v[48:49], v[48:49], s[72:73], v[82:83] op_sel_hi:[1,1,0] neg_lo:[0,0,1] neg_hi:[0,0,1]
    v_pk_fma_f32 v[62:63], v[62:63], s[72:73], v[102:103] op_sel_hi:[1,1,0] neg_lo:[0,0,1] neg_hi:[0,0,1]
    v_pk_fma_f32 v[64:65], v[64:65], s[72:73], v[102:103] op_sel_hi:[1,1,0] neg_lo:[0,0,1] neg_hi:[0,0,1]
    v_pk_fma_f32 v[66:67], v[66:67], s[72:73], v[102:103] op_sel_hi:[1,1,0] neg_lo:[0,0,1] neg_hi:[0,0,1]
    v_pk_fma_f32 v[68:69], v[68:69], s[72:73], v[102:103] op_sel_hi:[1,1,0] neg_lo:[0,0,1] neg_hi:[0,0,1]
    v_exp_f32 v16, v16
    v_exp_f32 v17, v17
    v_exp_f32 v18, v18
    v_exp_f32 v19, v19
    v_exp_f32 v20, v20
    v_exp_f32 v21, v21
    v_exp_f32 v22, v22
    v_exp_f32 v23, v23
    v_exp_f32 v24, v24
    v_exp_f32 v25, v25
    v_exp_f32 v26, v26
    v_exp_f32 v27, v27
    v_exp_f32 v28, v28
    v_exp_f32 v29, v29
    v_exp_f32 v30, v30
    v_exp_f32 v31, v31
    v_exp_f32 v42, v42
    v_exp_f32 v43, v43
    v_exp_f32 v44, v44
    v_exp_f32 v45, v45
    v_exp_f32 v46, v46
    v_exp_f32 v47, v47
    v_exp_f32 v48, v48
    v_exp_f32 v49, v49
    v_exp_f32 v62, v62
    v_exp_f32 v63, v63
    v_exp_f32 v64, v64
    v_exp_f32 v65, v65
    v_exp_f32 v66, v66
    v_exp_f32 v67, v67
    v_exp_f32 v68, v68
    v_exp_f32 v69, v69
    s_nop 0
    v_cvt_pk_bf16_f32 v16, v16, v17
    v_cvt_pk_bf16_f32 v17, v18, v19
    v_cvt_pk_bf16_f32 v18, v20, v21
    v_cvt_pk_bf16_f32 v19, v22, v23
    v_cvt_pk_bf16_f32 v24, v24, v25
    v_cvt_pk_bf16_f32 v25, v26, v27
    v_cvt_pk_bf16_f32 v26, v28, v29
    v_cvt_pk_bf16_f32 v27, v30, v31
    v_cvt_pk_bf16_f32 v42, v42, v43
    v_cvt_pk_bf16_f32 v43, v44, v45
    v_cvt_pk_bf16_f32 v44, v46, v47
    v_cvt_pk_bf16_f32 v45, v48, v49
    v_cvt_pk_bf16_f32 v62, v62, v63
    v_cvt_pk_bf16_f32 v63, v64, v65
    v_cvt_pk_bf16_f32 v64, v66, v67
    v_cvt_pk_bf16_f32 v65, v68, v69
    s_nop 1
    v_mfma_f32_16x16x32_bf16 v[136:139], v[128:131], v[16:19], 0
    v_mfma_f32_16x16x32_bf16 v[84:87], v[76:79], v[16:19], 0
    v_mfma_f32_16x16x32_bf16 v[140:143], v[128:131], v[24:27], 0
    v_mfma_f32_16x16x32_bf16 v[88:91], v[74:77], v[24:27], 0
    v_mfma_f32_16x16x32_bf16 v[146:149], v[128:131], v[42:45], 0
    v_mfma_f32_16x16x32_bf16 v[104:107], v[78:81], v[42:45], 0
    v_mfma_f32_16x16x32_bf16 v[150:153], v[128:131], v[62:65], 0
    v_mfma_f32_16x16x32_bf16 v[108:111], v[72:75], v[62:65], 0
    s_nop 7
    v_mul_f32 v136, v136, v132
    v_mul_f32 v140, v140, v133
    v_mul_f32 v146, v146, v134
    v_mul_f32 v150, v150, v135
    v_rcp_f32 v136, v136
    v_rcp_f32 v140, v140
    v_rcp_f32 v146, v146
    v_rcp_f32 v150, v150
    s_nop 0
    v_pk_mul_f32 v[84:85], v[84:85], v[136:137] op_sel_hi:[1,0]
    v_pk_mul_f32 v[86:87], v[86:87], v[136:137] op_sel_hi:[1,0]
    v_pk_mul_f32 v[88:89], v[88:89], v[140:141] op_sel_hi:[1,0]
    v_pk_mul_f32 v[90:91], v[90:91], v[140:141] op_sel_hi:[1,0]
    v_pk_mul_f32 v[104:105], v[104:105], v[146:147] op_sel_hi:[1,0]
    v_pk_mul_f32 v[106:107], v[106:107], v[146:147] op_sel_hi:[1,0]
    v_pk_mul_f32 v[108:109], v[108:109], v[150:151] op_sel_hi:[1,0]
    v_pk_mul_f32 v[110:111], v[110:111], v[150:151] op_sel_hi:[1,0]
    v_cvt_pk_bf16_f32 v0, v84, v85
    v_cvt_pk_bf16_f32 v1, v86, v87
    v_cvt_pk_bf16_f32 v2, v88, v89
    v_cvt_pk_bf16_f32 v3, v90, v91
    v_cvt_pk_bf16_f32 v4, v104, v105
    v_cvt_pk_bf16_f32 v5, v106, v107
    v_cvt_pk_bf16_f32 v6, v108, v109
    v_cvt_pk_bf16_f32 v7, v110, v111
    v_mfma_f32_16x16x16_bf16 v[20:23], v[52:53], v[8:9], v[112:115]
    v_mfma_f32_16x16x16_bf16 v[16:19], v[60:61], v[8:9], v[124:127]
    v_mfma_f32_16x16x16_bf16 v[24:27], v[54:55], v[10:11], v[112:115]
    v_mfma_f32_16x16x16_bf16 v[28:31], v[60:61], v[10:11], v[120:123]
    v_mfma_f32_16x16x16_bf16 v[46:49], v[56:57], v[12:13], v[112:115]
    v_mfma_f32_16x16x16_bf16 v[42:45], v[52:53], v[12:13], v[116:119]
    v_mfma_f32_16x16x16_bf16 v[62:65], v[58:59], v[14:15], v[112:115]
    v_mfma_f32_16x16x16_bf16 v[66:69], v[54:55], v[14:15], v[116:119]
    s_nop 7
    v_max3_f32 v50, v16, v17, v18
    v_max3_f32 v51, v19, v20, v21
    v_max3_f32 v70, v24, v25, v26
    v_max3_f32 v71, v27, v28, v29
    v_max3_f32 v82, v42, v43, v44
    v_max3_f32 v83, v45, v46, v47
    v_max3_f32 v102, v62, v63, v64
    v_max3_f32 v103, v65, v66, v67
    v_max3_f32 v50, v50, v22, v23
    v_max3_f32 v70, v70, v30, v31
    v_max3_f32 v82, v82, v48, v49
    v_max3_f32 v102, v102, v68, v69
    v_max_f32 v50, v50, v51
    v_max_f32 v70, v70, v71
    v_max_f32 v82, v82, v83
    v_max_f32 v102, v102, v103
    v_mov_b32 v51, v50
    v_mov_b32 v71, v70
    v_mov_b32 v83, v82
    v_mov_b32 v103, v102
    s_nop 1
    v_permlane16_swap_b32 v51, v50
    v_permlane16_swap_b32 v71, v70
    v_permlane16_swap_b32 v83, v82
    v_permlane16_swap_b32 v103, v102
    s_nop 1
    v_max_f32 v50, v50, v51
    v_max_f32 v70, v70, v71
    v_max_f32 v82, v82, v83
    v_max_f32 v102, v102, v103
    v_mov_b32 v51, v50
    v_mov_b32 v71, v70
    v_mov_b32 v83, v82
    v_mov_b32 v103, v102
    s_nop 1
    v_permlane32_swap_b32 v51, v50
    v_permlane32_swap_b32 v71, v70
    v_permlane32_swap_b32 v83, v82
    v_permlane32_swap_b32 v103, v102
    s_nop 1
    v_max_f32 v50, v50, v51
    v_max_f32 v70, v70, v71
    v_max_f32 v82, v82, v83
    v_max_f32 v102, v102, v103
    v_mul_f32 v50, s72, v50
    v_mul_f32 v70, s72, v70
    v_mul_f32 v82, s72, v82
    v_mul_f32 v102, s72, v102
    v_pk_fma_f32 v[16:17], v[16:17], s[72:73], v[50:51] op_sel_hi:[1,1,0] neg_lo:[0,0,1] neg_hi:[0,0,1]
    v_pk_fma_f32 v[18:19], v[18:19], s[72:73], v[50:51] op_sel_hi:[1,1,0] neg_lo:[0,0,1] neg_hi:[0,0,1]
    v_pk_fma_f32 v[20:21], v[20:21], s[72:73], v[50:51] op_sel_hi:[1,1,0] neg_lo:[0,0,1] neg_hi:[0,0,1]
    v_pk_fma_f32 v[22:23], v[22:23], s[72:73], v[50:51] op_sel_hi:[1,1,0] neg_lo:[0,0,1] neg_hi:[0,0,1]
    v_pk_fma_f32 v[24:25], v[24:25], s[72:73], v[70:71] op_sel_hi:[1,1,0] neg_lo:[0,0,1] neg_hi:[0,0,1]
    v_pk_fma_f32 v[26:27], v[26:27], s[72:73], v[70:71] op_sel_hi:[1,1,0] neg_lo:[0,0,1] neg_hi:[0,0,1]
    v_pk_fma_f32 v[28:29], v[28:29], s[72:73], v[70:71] op_sel_hi:[1,1,0] neg_lo:[0,0,1] neg_hi:[0,0,1]
    v_pk_fma_f32 v[30:31], v[30:31], s[72:73], v[70:71] op_sel_hi:[1,1,0] neg_lo:[0,0,1] neg_hi:[0,0,1]
    v_pk_fma_f32 v[42:43], v[42:43], s[72:73], v[82:83] op_sel_hi:[1,1,0] neg_lo:[0,0,1] neg_hi:[0,0,1]
    v_pk_fma_f32 v[44:45], v[44:45], s[72:73], v[82:83] op_sel_hi:[1,1,0] neg_lo:[0,0,1] neg_hi:[0,0,1]
    v_pk_fma_f32 v[46:47], v[46:47], s[72:73], v[82:83] op_sel_hi:[1,1,0] neg_lo:[0,0,1] neg_hi:[0,0,1]
    v_pk_fma_f32 v[48:49], v[48:49], s[72:73], v[82:83] op_sel_hi:[1,1,0] neg_lo:[0,0,1] neg_hi:[0,0,1]
    v_pk_fma_f32 v[62:63], v[62:63], s[72:73], v[102:103] op_sel_hi:[1,1,0] neg_lo:[0,0,1] neg_hi:[0,0,1]
    v_pk_fma_f32 v[64:65], v[64:65], s[72:73], v[102:103] op_sel_hi:[1,1,0] neg_lo:[0,0,1] neg_hi:[0,0,1]
    v_pk_fma_f32 v[66:67], v[66:67], s[72:73], v[102:103] op_sel_hi:[1,1,0] neg_lo:[0,0,1] neg_hi:[0,0,1]
    v_pk_fma_f32 v[68:69], v[68:69], s[72:73], v[102:103] op_sel_hi:[1,1,0] neg_lo:[0,0,1] neg_hi:[0,0,1]
    v_exp_f32 v16, v16
    v_exp_f32 v17, v17
    v_exp_f32 v18, v18
    v_exp_f32 v19, v19
    v_exp_f32 v20, v20
    v_exp_f32 v21, v21
    v_exp_f32 v22, v22
    v_exp_f32 v23, v23
    v_exp_f32 v24, v24
    v_exp_f32 v25, v25
    v_exp_f32 v26, v26
    v_exp_f32 v27, v27
    v_exp_f32 v28, v28
    v_exp_f32 v29, v29
    v_exp_f32 v30, v30
    v_exp_f32 v31, v31
    v_exp_f32 v42, v42
    v_exp_f32 v43, v43
    v_exp_f32 v44, v44
    v_exp_f32 v45, v45
    v_exp_f32 v46, v46
    v_exp_f32 v47, v47
    v_exp_f32 v48, v48
    v_exp_f32 v49, v49
    v_exp_f32 v62, v62
    v_exp_f32 v63, v63
    v_exp_f32 v64, v64
    v_exp_f32 v65, v65
    v_exp_f32 v66, v66
    v_exp_f32 v67, v67
    v_exp_f32 v68, v68
    v_exp_f32 v69, v69
    s_nop 0
    v_cvt_pk_bf16_f32 v16, v16, v17
    v_cvt_pk_bf16_f32 v17, v18, v19
    v_cvt_pk_bf16_f32 v18, v20, v21
    v_cvt_pk_bf16_f32 v19, v22, v23
    v_cvt_pk_bf16_f32 v24, v24, v25
    v_cvt_pk_bf16_f32 v25, v26, v27
    v_cvt_pk_bf16_f32 v26, v28, v29
    v_cvt_pk_bf16_f32 v27, v30, v31
    v_cvt_pk_bf16_f32 v42, v42, v43
    v_cvt_pk_bf16_f32 v43, v44, v45
    v_cvt_pk_bf16_f32 v44, v46, v47
    v_cvt_pk_bf16_f32 v45, v48, v49
    v_cvt_pk_bf16_f32 v62, v62, v63
    v_cvt_pk_bf16_f32 v63, v64, v65
    v_cvt_pk_bf16_f32 v64, v66, v67
    v_cvt_pk_bf16_f32 v65, v68, v69
    s_nop 1
    v_mfma_f32_16x16x32_bf16 v[136:139], v[128:131], v[16:19], 0
    v_mfma_f32_16x16x32_bf16 v[84:87], v[96:99], v[16:19], 0
    v_mfma_f32_16x16x32_bf16 v[140:143], v[128:131], v[24:27], 0
    v_mfma_f32_16x16x32_bf16 v[88:91], v[94:97], v[24:27], 0
    v_mfma_f32_16x16x32_bf16 v[146:149], v[128:131], v[42:45], 0
    v_mfma_f32_16x16x32_bf16 v[104:107], v[98:101], v[42:45], 0
    v_mfma_f32_16x16x32_bf16 v[150:153], v[128:131], v[62:65], 0
    v_mfma_f32_16x16x32_bf16 v[108:111], v[92:95], v[62:65], 0
    s_nop 7
    v_mul_f32 v136, v136, v132
    v_mul_f32 v140, v140, v133
    v_mul_f32 v146, v146, v134
    v_mul_f32 v150, v150, v135
    v_rcp_f32 v136, v136
    v_rcp_f32 v140, v140
    v_rcp_f32 v146, v146
    v_rcp_f32 v150, v150
    s_nop 0
    v_pk_mul_f32 v[84:85], v[84:85], v[136:137] op_sel_hi:[1,0]
    v_pk_mul_f32 v[86:87], v[86:87], v[136:137] op_sel_hi:[1,0]
    v_pk_mul_f32 v[88:89], v[88:89], v[140:141] op_sel_hi:[1,0]
    v_pk_mul_f32 v[90:91], v[90:91], v[140:141] op_sel_hi:[1,0]
    v_pk_mul_f32 v[104:105], v[104:105], v[146:147] op_sel_hi:[1,0]
    v_pk_mul_f32 v[106:107], v[106:107], v[146:147] op_sel_hi:[1,0]
    v_pk_mul_f32 v[108:109], v[108:109], v[150:151] op_sel_hi:[1,0]
    v_pk_mul_f32 v[110:111], v[110:111], v[150:151] op_sel_hi:[1,0]
    v_mov_b32 v16, v0
    v_mov_b32 v17, v1
    v_cvt_pk_bf16_f32 v18, v84, v85
    v_cvt_pk_bf16_f32 v19, v86, v87
    buffer_store_dwordx4 v[16:19], v145, s[44:47], s78 offen offset:0 sc1
    v_mov_b32 v24, v2
    v_mov_b32 v25, v3
    v_cvt_pk_bf16_f32 v26, v88, v89
    v_cvt_pk_bf16_f32 v27, v90, v91
    buffer_store_dwordx4 v[24:27], v145, s[44:47], s78 offen offset:1024 sc1
    v_mov_b32 v42, v4
    v_mov_b32 v43, v5
    v_cvt_pk_bf16_f32 v44, v104, v105
    v_cvt_pk_bf16_f32 v45, v106, v107
    buffer_store_dwordx4 v[42:45], v145, s[44:47], s78 offen offset:2048 sc1
    v_mov_b32 v62, v6
    v_mov_b32 v63, v7
    v_cvt_pk_bf16_f32 v64, v108, v109
    v_cvt_pk_bf16_f32 v65, v110, v111
    buffer_store_dwordx4 v[62:65], v145, s[44:47], s78 offen offset:3072 sc1
L_CDONE:
    s_lshl_b32 s68, s67, 2
    v_mov_b32 v156, s68
    ds_read_b32 v155, v156 offset:1536
    s_lshr_b32 s68, s65, 1
    s_lshl_b32 s68, s68, 4
    s_add_u32 s68, s68, s10
    s_lshl_b32 s68, s68, 8
    s_and_b32 s70, s65, 1
    s_lshl_b32 s70, s70, 7
    s_add_u32 s68, s68, s70
    s_add_u32 s82, s68, 9502720
    v_and_b32 v159, 1, v144
    v_and_b32 v149, 2, v144
    v_lshlrev_b32 v159, 2, v159
    v_lshl_add_u32 v159, v149, 10, v159
    v_lshlrev_b32 v149, 4, v144
    s_mul_i32 s78, s65, 294912
    s_lshl_b32 s70, s10, 13
    s_add_u32 s79, s78, s70
    s_add_u32 s79, s79, 229376
    s_mul_i32 s70, s10, 28672
    s_add_u32 s78, s78, s70
    s_mov_b32 s56, s18
    s_mov_b32 s57, s19
    s_mov_b32 s58, 1024
    s_mov_b32 s59, 0x00020000
    s_lshl_b32 s68, s77, 8
    s_lshl_b32 s69, s84, 7
    s_lshl_b32 s70, s85, 2
    s_add_u32 s68, s68, s69
    s_add_u32 s70, s70, 9502720
    s_add_u32 s76, s68, s70
    v_readfirstlane_b32 s11, v158
    v_lshrrev_b32 v150, 2, v144
    v_and_b32 v151, 3, v144
    v_lshlrev_b32 v145, 7, v150
    v_lshl_add_u32 v145, v151, 3, v145
    v_bfe_u32 v150, v150, 1, 2
    v_lshl_add_u32 v145, v150, 5, v145
    s_lshl_b32 s68, s67, 12
    s_add_u32 s68, s68, 4096
    v_add_u32 v145, s68, v145
    v_xor_b32 v146, 32, v145
    v_xor_b32 v147, 64, v145
    v_xor_b32 v148, 0x60, v145
    s_mov_b32 s77, 0
    s_waitcnt lgkmcnt(0)
    v_cmp_ne_u32 vcc, 1, v155
    s_cbranch_vccz L_CDRAIN
    s_waitcnt vmcnt(0)
    s_mov_b64 exec, 1
    buffer_store_dword v158, off, s[44:47], s76 sc1
    s_mov_b64 exec, -1
    s_mov_b32 s77, 1
    s_mov_b32 s69, 262144
L_LW_5:
    ds_read_b32 v155, v156 offset:1536
    s_sub_u32 s69, s69, 1
    s_cbranch_scc1 L_LWX_6
    s_waitcnt lgkmcnt(0)
    v_cmp_ne_u32 vcc, 1, v155
    s_cbranch_vccnz L_LW_5
L_LWX_6:
L_CDRAIN:
    buffer_load_dword v157, v159, s[44:47], s82 offen sc1
    ds_read_b64_tr_b16 v[96:97], v145 offset:0
    ds_read_b64_tr_b16 v[98:99], v145 offset:2048
    ds_read_b64_tr_b16 v[100:101], v146 offset:0
    ds_read_b64_tr_b16 v[102:103], v146 offset:2048
    ds_read_b64_tr_b16 v[104:105], v147 offset:0
    ds_read_b64_tr_b16 v[106:107], v147 offset:2048
    ds_read_b64_tr_b16 v[108:109], v148 offset:0
    ds_read_b64_tr_b16 v[110:111], v148 offset:2048
    ds_read_b64_tr_b16 v[112:113], v145 offset:16384
    ds_read_b64_tr_b16 v[114:115], v145 offset:18432
    ds_read_b64_tr_b16 v[116:117], v146 offset:16384
    ds_read_b64_tr_b16 v[118:119], v146 offset:18432
    ds_read_b64_tr_b16 v[120:121], v147 offset:16384
    ds_read_b64_tr_b16 v[122:123], v147 offset:18432
    ds_read_b64_tr_b16 v[124:125], v148 offset:16384
    ds_read_b64_tr_b16 v[126:127], v148 offset:18432
    ds_read_b64_tr_b16 v[128:129], v145 offset:32768
    ds_read_b64_tr_b16 v[130:131], v145 offset:34816
    ds_read_b64_tr_b16 v[132:133], v146 offset:32768
    ds_read_b64_tr_b16 v[134:135], v146 offset:34816
    ds_read_b64_tr_b16 v[136:137], v147 offset:32768
    ds_read_b64_tr_b16 v[138:139], v147 offset:34816
    ds_read_b64_tr_b16 v[140:141], v148 offset:32768
    ds_read_b64_tr_b16 v[142:143], v148 offset:34816
    ds_read_b64_tr_b16 a[0:1], v145 offset:49152
    ds_read_b64_tr_b16 a[2:3], v145 offset:51200
    ds_read_b64_tr_b16 a[4:5], v146 offset:49152
    ds_read_b64_tr_b16 a[6:7], v146 offset:51200
    ds_read_b64_tr_b16 a[8:9], v147 offset:49152
    ds_read_b64_tr_b16 a[10:11], v147 offset:51200
    ds_read_b64_tr_b16 a[12:13], v148 offset:49152
    ds_read_b64_tr_b16 a[14:15], v148 offset:51200
    v_add_u32 v145, 0x10000, v145
    v_add_u32 v146, 0x10000, v146
    v_add_u32 v147, 0x10000, v147
    v_add_u32 v148, 0x10000, v148
    ds_read_b64_tr_b16 a[16:17], v145 offset:0
    ds_read_b64_tr_b16 a[18:19], v145 offset:2048
    ds_read_b64_tr_b16 a[20:21], v146 offset:0
    ds_read_b64_tr_b16 a[22:23], v146 offset:2048
    ds_read_b64_tr_b16 a[24:25], v147 offset:0
    ds_read_b64_tr_b16 a[26:27], v147 offset:2048
    ds_read_b64_tr_b16 a[28:29], v148 offset:0
    ds_read_b64_tr_b16 a[30:31], v148 offset:2048
    ds_read_b64_tr_b16 a[32:33], v145 offset:16384
    ds_read_b64_tr_b16 a[34:35], v145 offset:18432
    ds_read_b64_tr_b16 a[36:37], v146 offset:16384
    ds_read_b64_tr_b16 a[38:39], v146 offset:18432
    ds_read_b64_tr_b16 a[40:41], v147 offset:16384
    ds_read_b64_tr_b16 a[42:43], v147 offset:18432
    ds_read_b64_tr_b16 a[44:45], v148 offset:16384
    ds_read_b64_tr_b16 a[46:47], v148 offset:18432
    ds_read_b64_tr_b16 a[48:49], v145 offset:32768
    ds_read_b64_tr_b16 a[50:51], v145 offset:34816
    ds_read_b64_tr_b16 a[52:53], v146 offset:32768
    ds_read_b64_tr_b16 a[54:55], v146 offset:34816
    ds_read_b64_tr_b16 a[56:57], v147 offset:32768
    ds_read_b64_tr_b16 a[58:59], v147 offset:34816
    ds_read_b64_tr_b16 a[60:61], v148 offset:32768
    ds_read_b64_tr_b16 a[62:63], v148 offset:34816
    ds_read_b64_tr_b16 a[64:65], v145 offset:49152
    ds_read_b64_tr_b16 a[66:67], v145 offset:51200
    ds_read_b64_tr_b16 a[68:69], v146 offset:49152
    ds_read_b64_tr_b16 a[70:71], v146 offset:51200
    ds_read_b64_tr_b16 a[72:73], v147 offset:49152
    ds_read_b64_tr_b16 a[74:75], v147 offset:51200
    ds_read_b64_tr_b16 a[76:77], v148 offset:49152
    ds_read_b64_tr_b16 a[78:79], v148 offset:51200
    v_add_u32 v145, 0x10000, v145
    v_add_u32 v146, 0x10000, v146
    v_add_u32 v147, 0x10000, v147
    v_add_u32 v148, 0x10000, v148
    ds_read_b64_tr_b16 a[80:81], v145 offset:0
    ds_read_b64_tr_b16 a[82:83], v145 offset:2048
    ds_read_b64_tr_b16 a[84:85], v146 offset:0
    ds_read_b64_tr_b16 a[86:87], v146 offset:2048
    ds_read_b64_tr_b16 a[88:89], v147 offset:0
    ds_read_b64_tr_b16 a[90:91], v147 offset:2048
    ds_read_b64_tr_b16 a[92:93], v148 offset:0
    ds_read_b64_tr_b16 a[94:95], v148 offset:2048
    s_cmp_eq_u32 s77, 1
    s_cbranch_scc1 L_CPUB0
    s_waitcnt vmcnt(1)
    s_mov_b64 exec, 1
    buffer_store_dword v158, off, s[44:47], s76 sc1
    s_mov_b64 exec, -1
L_CPUBX:
    v_mov_b32 v151, 1
    s_waitcnt vmcnt(1) lgkmcnt(0)
    ds_write_b32 v156, v151 offset:1568
    s_setprio 0
L_P2:
    s_mov_b32 s69, 262144
L_PLC_9:
    v_cmp_ne_u32 vcc, s11, v157
    s_and_b32 s68, vcc_lo, 12
    s_cbranch_scc1 L_PL_7
L_PLX_8:
    s_and_b32 s77, vcc_lo, 3
    s_xor_b32 s71, s3, 0
    s_lshl_b32 s71, s71, 12
    s_add_u32 s71, s71, s79
    buffer_load_dwordx4 v[64:67], v149, s[44:47], s71 offen offset:0 sc1
    buffer_load_dwordx4 v[68:71], v149, s[44:47], s71 offen offset:1024 sc1
    buffer_load_dwordx4 v[72:75], v149, s[44:47], s71 offen offset:2048 sc1
    buffer_load_dwordx4 v[76:79], v149, s[44:47], s71 offen offset:3072 sc1
    s_xor_b32 s71, s3, 1
    s_lshl_b32 s71, s71, 12
    s_add_u32 s71, s71, s79
    buffer_load_dwordx4 v[80:83], v149, s[44:47], s71 offen offset:0 sc1
    buffer_load_dwordx4 v[84:87], v149, s[44:47], s71 offen offset:1024 sc1
    buffer_load_dwordx4 v[88:91], v149, s[44:47], s71 offen offset:2048 sc1
    buffer_load_dwordx4 v[92:95], v149, s[44:47], s71 offen offset:3072 sc1
L_P2B:
    s_cmp_eq_u32 s77, 0
    s_cbranch_scc1 L_FAST
    buffer_load_dword v157, v159, s[44:47], s82 offen sc1
    s_waitcnt vmcnt(5) lgkmcnt(0)
    v_mfma_f32_16x16x32_bf16 v[0:3], v[96:99], v[64:67], 0
    v_mfma_f32_16x16x32_bf16 v[4:7], v[100:103], v[64:67], 0
    v_mfma_f32_16x16x32_bf16 v[8:11], v[104:107], v[64:67], 0
    v_mfma_f32_16x16x32_bf16 v[12:15], v[108:111], v[64:67], 0
    v_mfma_f32_16x16x32_bf16 v[16:19], v[96:99], v[68:71], 0
    v_mfma_f32_16x16x32_bf16 v[20:23], v[100:103], v[68:71], 0
    v_mfma_f32_16x16x32_bf16 v[24:27], v[104:107], v[68:71], 0
    v_mfma_f32_16x16x32_bf16 v[28:31], v[108:111], v[68:71], 0
    v_mfma_f32_16x16x32_bf16 v[32:35], v[96:99], v[72:75], 0
    v_mfma_f32_16x16x32_bf16 v[36:39], v[100:103], v[72:75], 0
    v_mfma_f32_16x16x32_bf16 v[40:43], v[104:107], v[72:75], 0
    v_mfma_f32_16x16x32_bf16 v[44:47], v[108:111], v[72:75], 0
    v_mfma_f32_16x16x32_bf16 v[48:51], v[96:99], v[76:79], 0
    v_mfma_f32_16x16x32_bf16 v[52:55], v[100:103], v[76:79], 0
    v_mfma_f32_16x16x32_bf16 v[56:59], v[104:107], v[76:79], 0
    v_mfma_f32_16x16x32_bf16 v[60:63], v[108:111], v[76:79], 0
    s_waitcnt vmcnt(1)
    v_mfma_f32_16x16x32_bf16 v[0:3], v[112:115], v[80:83], v[0:3]
    v_mfma_f32_16x16x32_bf16 v[4:7], v[116:119], v[80:83], v[4:7]
    v_mfma_f32_16x16x32_bf16 v[8:11], v[120:123], v[80:83], v[8:11]
    v_mfma_f32_16x16x32_bf16 v[12:15], v[124:127], v[80:83], v[12:15]
    v_mfma_f32_16x16x32_bf16 v[16:19], v[112:115], v[84:87], v[16:19]
    v_mfma_f32_16x16x32_bf16 v[20:23], v[116:119], v[84:87], v[20:23]
    v_mfma_f32_16x16x32_bf16 v[24:27], v[120:123], v[84:87], v[24:27]
    v_mfma_f32_16x16x32_bf16 v[28:31], v[124:127], v[84:87], v[28:31]
    v_mfma_f32_16x16x32_bf16 v[32:35], v[112:115], v[88:91], v[32:35]
    v_mfma_f32_16x16x32_bf16 v[36:39], v[116:119], v[88:91], v[36:39]
    v_mfma_f32_16x16x32_bf16 v[40:43], v[120:123], v[88:91], v[40:43]
    v_mfma_f32_16x16x32_bf16 v[44:47], v[124:127], v[88:91], v[44:47]
    v_mfma_f32_16x16x32_bf16 v[48:51], v[112:115], v[92:95], v[48:51]
    v_mfma_f32_16x16x32_bf16 v[52:55], v[116:119], v[92:95], v[52:55]
    v_mfma_f32_16x16x32_bf16 v[56:59], v[120:123], v[92:95], v[56:59]
    v_mfma_f32_16x16x32_bf16 v[60:63], v[124:127], v[92:95], v[60:63]
    s_waitcnt vmcnt(0)
    s_mov_b32 s69, 262144
L_PLC_12:
    v_cmp_ne_u32 vcc, s11, v157
    s_and_b32 s68, vcc_lo, 3
    s_cbranch_scc1 L_PL_10
L_PLX_11:
    s_add_u32 s71, s75, 0
    s_sub_u32 s73, s71, 7
    s_cselect_b32 s71, s71, s73
    s_lshl_b32 s71, s71, 12
    s_add_u32 s71, s71, s78
    buffer_load_dwordx4 v[64:67], v149, s[44:47], s71 offen offset:0 sc1
    buffer_load_dwordx4 v[68:71], v149, s[44:47], s71 offen offset:1024 sc1
    buffer_load_dwordx4 v[72:75], v149, s[44:47], s71 offen offset:2048 sc1
    buffer_load_dwordx4 v[76:79], v149, s[44:47], s71 offen offset:3072 sc1
    s_add_u32 s71, s75, 1
    s_sub_u32 s73, s71, 7
    s_cselect_b32 s71, s71, s73
    s_lshl_b32 s71, s71, 12
    s_add_u32 s71, s71, s78
    buffer_load_dwordx4 v[96:99], v149, s[44:47], s71 offen offset:0 sc1
    buffer_load_dwordx4 v[100:103], v149, s[44:47], s71 offen offset:1024 sc1
    buffer_load_dwordx4 v[104:107], v149, s[44:47], s71 offen offset:2048 sc1
    buffer_load_dwordx4 v[108:111], v149, s[44:47], s71 offen offset:3072 sc1
    s_add_u32 s71, s75, 2
    s_sub_u32 s73, s71, 7
    s_cselect_b32 s71, s71, s73
    s_lshl_b32 s71, s71, 12
    s_add_u32 s71, s71, s78
    buffer_load_dwordx4 v[80:83], v149, s[44:47], s71 offen offset:0 sc1
    buffer_load_dwordx4 v[84:87], v149, s[44:47], s71 offen offset:1024 sc1
    buffer_load_dwordx4 v[88:91], v149, s[44:47], s71 offen offset:2048 sc1
    buffer_load_dwordx4 v[92:95], v149, s[44:47], s71 offen offset:3072 sc1
    s_add_u32 s71, s75, 3
    s_sub_u32 s73, s71, 7
    s_cselect_b32 s71, s71, s73
    s_lshl_b32 s71, s71, 12
    s_add_u32 s71, s71, s78
    buffer_load_dwordx4 v[112:115], v149, s[44:47], s71 offen offset:0 sc1
    buffer_load_dwordx4 v[116:119], v149, s[44:47], s71 offen offset:1024 sc1
    buffer_load_dwordx4 v[120:123], v149, s[44:47], s71 offen offset:2048 sc1
    buffer_load_dwordx4 v[124:127], v149, s[44:47], s71 offen offset:3072 sc1
    s_branch L_MERGE
L_FAST:
    s_waitcnt vmcnt(4) lgkmcnt(0)
    v_mfma_f32_16x16x32_bf16 v[0:3], v[96:99], v[64:67], 0
    v_mfma_f32_16x16x32_bf16 v[4:7], v[100:103], v[64:67], 0
    v_mfma_f32_16x16x32_bf16 v[8:11], v[104:107], v[64:67], 0
    v_mfma_f32_16x16x32_bf16 v[12:15], v[108:111], v[64:67], 0
    v_mfma_f32_16x16x32_bf16 v[16:19], v[96:99], v[68:71], 0
    v_mfma_f32_16x16x32_bf16 v[20:23], v[100:103], v[68:71], 0
    v_mfma_f32_16x16x32_bf16 v[24:27], v[104:107], v[68:71], 0
    v_mfma_f32_16x16x32_bf16 v[28:31], v[108:111], v[68:71], 0
    v_mfma_f32_16x16x32_bf16 v[32:35], v[96:99], v[72:75], 0
    v_mfma_f32_16x16x32_bf16 v[36:39], v[100:103], v[72:75], 0
    v_mfma_f32_16x16x32_bf16 v[40:43], v[104:107], v[72:75], 0
    v_mfma_f32_16x16x32_bf16 v[44:47], v[108:111], v[72:75], 0
    v_mfma_f32_16x16x32_bf16 v[48:51], v[96:99], v[76:79], 0
    v_mfma_f32_16x16x32_bf16 v[52:55], v[100:103], v[76:79], 0
    v_mfma_f32_16x16x32_bf16 v[56:59], v[104:107], v[76:79], 0
    v_mfma_f32_16x16x32_bf16 v[60:63], v[108:111], v[76:79], 0
    s_add_u32 s71, s75, 0
    s_sub_u32 s73, s71, 7
    s_cselect_b32 s71, s71, s73
    s_lshl_b32 s71, s71, 12
    s_add_u32 s71, s71, s78
    buffer_load_dwordx4 v[64:67], v149, s[44:47], s71 offen offset:0 sc1
    buffer_load_dwordx4 v[68:71], v149, s[44:47], s71 offen offset:1024 sc1
    buffer_load_dwordx4 v[72:75], v149, s[44:47], s71 offen offset:2048 sc1
    buffer_load_dwordx4 v[76:79], v149, s[44:47], s71 offen offset:3072 sc1
    s_add_u32 s71, s75, 1
    s_sub_u32 s73, s71, 7
    s_cselect_b32 s71, s71, s73
    s_lshl_b32 s71, s71, 12
    s_add_u32 s71, s71, s78
    buffer_load_dwordx4 v[96:99], v149, s[44:47], s71 offen offset:0 sc1
    buffer_load_dwordx4 v[100:103], v149, s[44:47], s71 offen offset:1024 sc1
    buffer_load_dwordx4 v[104:107], v149, s[44:47], s71 offen offset:2048 sc1
    buffer_load_dwordx4 v[108:111], v149, s[44:47], s71 offen offset:3072 sc1
    s_waitcnt vmcnt(8)
    v_mfma_f32_16x16x32_bf16 v[0:3], v[112:115], v[80:83], v[0:3]
    v_mfma_f32_16x16x32_bf16 v[4:7], v[116:119], v[80:83], v[4:7]
    v_mfma_f32_16x16x32_bf16 v[8:11], v[120:123], v[80:83], v[8:11]
    v_mfma_f32_16x16x32_bf16 v[12:15], v[124:127], v[80:83], v[12:15]
    v_mfma_f32_16x16x32_bf16 v[16:19], v[112:115], v[84:87], v[16:19]
    v_mfma_f32_16x16x32_bf16 v[20:23], v[116:119], v[84:87], v[20:23]
    v_mfma_f32_16x16x32_bf16 v[24:27], v[120:123], v[84:87], v[24:27]
    v_mfma_f32_16x16x32_bf16 v[28:31], v[124:127], v[84:87], v[28:31]
    v_mfma_f32_16x16x32_bf16 v[32:35], v[112:115], v[88:91], v[32:35]
    v_mfma_f32_16x16x32_bf16 v[36:39], v[116:119], v[88:91], v[36:39]
    v_mfma_f32_16x16x32_bf16 v[40:43], v[120:123], v[88:91], v[40:43]
    v_mfma_f32_16x16x32_bf16 v[44:47], v[124:127], v[88:91], v[44:47]
    v_mfma_f32_16x16x32_bf16 v[48:51], v[112:115], v[92:95], v[48:51]
    v_mfma_f32_16x16x32_bf16 v[52:55], v[116:119], v[92:95], v[52:55]
    v_mfma_f32_16x16x32_bf16 v[56:59], v[120:123], v[92:95], v[56:59]
    v_mfma_f32_16x16x32_bf16 v[60:63], v[124:127], v[92:95], v[60:63]
    s_add_u32 s71, s75, 2
    s_sub_u32 s73, s71, 7
    s_cselect_b32 s71, s71, s73
    s_lshl_b32 s71, s71, 12
    s_add_u32 s71, s71, s78
    buffer_load_dwordx4 v[80:83], v149, s[44:47], s71 offen offset:0 sc1
    buffer_load_dwordx4 v[84:87], v149, s[44:47], s71 offen offset:1024 sc1
    buffer_load_dwordx4 v[88:91], v149, s[44:47], s71 offen offset:2048 sc1
    buffer_load_dwordx4 v[92:95], v149, s[44:47], s71 offen offset:3072 sc1
    s_add_u32 s71, s75, 3
    s_sub_u32 s73, s71, 7
    s_cselect_b32 s71, s71, s73
    s_lshl_b32 s71, s71, 12
    s_add_u32 s71, s71, s78
    buffer_load_dwordx4 v[112:115], v149, s[44:47], s71 offen offset:0 sc1
    buffer_load_dwordx4 v[116:119], v149, s[44:47], s71 offen offset:1024 sc1
    buffer_load_dwordx4 v[120:123], v149, s[44:47], s71 offen offset:2048 sc1
    buffer_load_dwordx4 v[124:127], v149, s[44:47], s71 offen offset:3072 sc1
L_MERGE:
    s_lshl_b32 s68, s65, 10
    s_lshl_b32 s70, s60, 7
    s_add_u32 s68, s68, s70
    s_add_u32 s68, s68, 9437184
    v_and_b32 v156, 0x38, v144
    buffer_load_dword v156, v156, s[44:47], s68 offen sc1
    v_and_b32 v150, 7, v144
    v_lshlrev_b32 v150, 4, v150
    s_lshl_b32 s70, s66, 7
    buffer_load_dwordx4 v[152:155], v150, s[56:59], s70 offen
    s_waitcnt vmcnt(14)
    s_cmp_eq_u32 s75, 3
    s_cbranch_scc1 L_SWP2
L_SWPX2:
    v_mfma_f32_16x16x32_bf16 v[0:3], v[128:131], v[64:67], v[0:3]
    v_mfma_f32_16x16x32_bf16 v[4:7], v[132:135], v[64:67], v[4:7]
    v_mfma_f32_16x16x32_bf16 v[8:11], v[136:139], v[64:67], v[8:11]
    v_mfma_f32_16x16x32_bf16 v[12:15], v[140:143], v[64:67], v[12:15]
    v_mfma_f32_16x16x32_bf16 v[16:19], v[128:131], v[68:71], v[16:19]
    v_mfma_f32_16x16x32_bf16 v[20:23], v[132:135], v[68:71], v[20:23]
    v_mfma_f32_16x16x32_bf16 v[24:27], v[136:139], v[68:71], v[24:27]
    v_mfma_f32_16x16x32_bf16 v[28:31], v[140:143], v[68:71], v[28:31]
    v_mfma_f32_16x16x32_bf16 v[32:35], v[128:131], v[72:75], v[32:35]
    v_mfma_f32_16x16x32_bf16 v[36:39], v[132:135], v[72:75], v[36:39]
    v_mfma_f32_16x16x32_bf16 v[40:43], v[136:139], v[72:75], v[40:43]
    v_mfma_f32_16x16x32_bf16 v[44:47], v[140:143], v[72:75], v[44:47]
    v_mfma_f32_16x16x32_bf16 v[48:51], v[128:131], v[76:79], v[48:51]
    v_mfma_f32_16x16x32_bf16 v[52:55], v[132:135], v[76:79], v[52:55]
    v_mfma_f32_16x16x32_bf16 v[56:59], v[136:139], v[76:79], v[56:59]
    v_mfma_f32_16x16x32_bf16 v[60:63], v[140:143], v[76:79], v[60:63]
    s_add_u32 s71, s75, 4
    s_sub_u32 s73, s71, 7
    s_cselect_b32 s71, s71, s73
    s_lshl_b32 s71, s71, 12
    s_add_u32 s71, s71, s78
    buffer_load_dwordx4 v[64:67], v149, s[44:47], s71 offen offset:0 sc1
    buffer_load_dwordx4 v[68:71], v149, s[44:47], s71 offen offset:1024 sc1
    buffer_load_dwordx4 v[72:75], v149, s[44:47], s71 offen offset:2048 sc1
    buffer_load_dwordx4 v[76:79], v149, s[44:47], s71 offen offset:3072 sc1
    s_add_u32 s71, s75, 5
    s_sub_u32 s73, s71, 7
    s_cselect_b32 s71, s71, s73
    s_lshl_b32 s71, s71, 12
    s_add_u32 s71, s71, s78
    buffer_load_dwordx4 v[128:131], v149, s[44:47], s71 offen offset:0 sc1
    buffer_load_dwordx4 v[132:135], v149, s[44:47], s71 offen offset:1024 sc1
    buffer_load_dwordx4 v[136:139], v149, s[44:47], s71 offen offset:2048 sc1
    buffer_load_dwordx4 v[140:143], v149, s[44:47], s71 offen offset:3072 sc1
    s_waitcnt vmcnt(18)
    s_cmp_eq_u32 s75, 2
    s_cbranch_scc1 L_SWP3
L_SWPX3:
    v_mfma_f32_16x16x32_bf16 v[0:3], a[0:3], v[96:99], v[0:3]
    v_mfma_f32_16x16x32_bf16 v[4:7], a[4:7], v[96:99], v[4:7]
    v_mfma_f32_16x16x32_bf16 v[8:11], a[8:11], v[96:99], v[8:11]
    v_mfma_f32_16x16x32_bf16 v[12:15], a[12:15], v[96:99], v[12:15]
    v_mfma_f32_16x16x32_bf16 v[16:19], a[0:3], v[100:103], v[16:19]
    v_mfma_f32_16x16x32_bf16 v[20:23], a[4:7], v[100:103], v[20:23]
    v_mfma_f32_16x16x32_bf16 v[24:27], a[8:11], v[100:103], v[24:27]
    v_mfma_f32_16x16x32_bf16 v[28:31], a[12:15], v[100:103], v[28:31]
    v_mfma_f32_16x16x32_bf16 v[32:35], a[0:3], v[104:107], v[32:35]
    v_mfma_f32_16x16x32_bf16 v[36:39], a[4:7], v[104:107], v[36:39]
    v_mfma_f32_16x16x32_bf16 v[40:43], a[8:11], v[104:107], v[40:43]
    v_mfma_f32_16x16x32_bf16 v[44:47], a[12:15], v[104:107], v[44:47]
    v_mfma_f32_16x16x32_bf16 v[48:51], a[0:3], v[108:111], v[48:51]
    v_mfma_f32_16x16x32_bf16 v[52:55], a[4:7], v[108:111], v[52:55]
    v_mfma_f32_16x16x32_bf16 v[56:59], a[8:11], v[108:111], v[56:59]
    v_mfma_f32_16x16x32_bf16 v[60:63], a[12:15], v[108:111], v[60:63]
    s_add_u32 s71, s75, 6
    s_sub_u32 s73, s71, 7
    s_cselect_b32 s71, s71, s73
    s_lshl_b32 s71, s71, 12
    s_add_u32 s71, s71, s78
    buffer_load_dwordx4 v[96:99], v149, s[44:47], s71 offen offset:0 sc1
    buffer_load_dwordx4 v[100:103], v149, s[44:47], s71 offen offset:1024 sc1
    buffer_load_dwordx4 v[104:107], v149, s[44:47], s71 offen offset:2048 sc1
    buffer_load_dwordx4 v[108:111], v149, s[44:47], s71 offen offset:3072 sc1
    v_and_b32 v150, 15, v144
    v_lshrrev_b32 v151, 4, v144
    v_and_b32 v157, 2, v151
    v_xor_b32 v150, v150, v157
    v_lshlrev_b32 v150, 4, v150
    v_lshl_add_u32 v150, v151, 8, v150
    s_lshl_b32 s68, s67, 12
    s_add_u32 s68, s68, 4096
    s_cmp_lt_u32 s60, 4
    s_cselect_b32 s70, 0x10000, 0
    s_add_u32 s68, s68, s70
    v_add_u32 v145, s68, v150
    v_xor_b32 v146, 64, v145
    v_add_u32 v146, 1024, v146
    v_xor_b32 v147, 128, v145
    v_add_u32 v147, 2048, v147
    v_xor_b32 v148, 192, v145
    v_add_u32 v148, 3072, v148
    s_waitcnt vmcnt(18)
    s_cmp_eq_u32 s75, 1
    s_cbranch_scc1 L_SWP4
L_SWPX4:
    v_mfma_f32_16x16x32_bf16 v[0:3], a[16:19], v[80:83], v[0:3]
    v_mfma_f32_16x16x32_bf16 v[4:7], a[20:23], v[80:83], v[4:7]
    v_mfma_f32_16x16x32_bf16 v[8:11], a[24:27], v[80:83], v[8:11]
    v_mfma_f32_16x16x32_bf16 v[12:15], a[28:31], v[80:83], v[12:15]
    v_mfma_f32_16x16x32_bf16 v[16:19], a[16:19], v[84:87], v[16:19]
    v_mfma_f32_16x16x32_bf16 v[20:23], a[20:23], v[84:87], v[20:23]
    v_mfma_f32_16x16x32_bf16 v[24:27], a[24:27], v[84:87], v[24:27]
    v_mfma_f32_16x16x32_bf16 v[28:31], a[28:31], v[84:87], v[28:31]
    v_mfma_f32_16x16x32_bf16 v[32:35], a[16:19], v[88:91], v[32:35]
    v_mfma_f32_16x16x32_bf16 v[36:39], a[20:23], v[88:91], v[36:39]
    v_mfma_f32_16x16x32_bf16 v[40:43], a[24:27], v[88:91], v[40:43]
    v_mfma_f32_16x16x32_bf16 v[44:47], a[28:31], v[88:91], v[44:47]
    v_mfma_f32_16x16x32_bf16 v[48:51], a[16:19], v[92:95], v[48:51]
    v_mfma_f32_16x16x32_bf16 v[52:55], a[20:23], v[92:95], v[52:55]
    v_mfma_f32_16x16x32_bf16 v[56:59], a[24:27], v[92:95], v[56:59]
    v_mfma_f32_16x16x32_bf16 v[60:63], a[28:31], v[92:95], v[60:63]
    s_waitcnt vmcnt(14)
    s_cmp_eq_u32 s75, 0
    s_cbranch_scc1 L_SWP5
L_SWPX5:
    v_mfma_f32_16x16x32_bf16 v[0:3], a[32:35], v[112:115], v[0:3]
    v_mfma_f32_16x16x32_bf16 v[4:7], a[36:39], v[112:115], v[4:7]
    v_mfma_f32_16x16x32_bf16 v[8:11], a[40:43], v[112:115], v[8:11]
    v_mfma_f32_16x16x32_bf16 v[12:15], a[44:47], v[112:115], v[12:15]
    v_mfma_f32_16x16x32_bf16 v[16:19], a[32:35], v[116:119], v[16:19]
    v_mfma_f32_16x16x32_bf16 v[20:23], a[36:39], v[116:119], v[20:23]
    v_mfma_f32_16x16x32_bf16 v[24:27], a[40:43], v[116:119], v[24:27]
    v_mfma_f32_16x16x32_bf16 v[28:31], a[44:47], v[116:119], v[28:31]
    v_mfma_f32_16x16x32_bf16 v[32:35], a[32:35], v[120:123], v[32:35]
    v_mfma_f32_16x16x32_bf16 v[36:39], a[36:39], v[120:123], v[36:39]
    v_mfma_f32_16x16x32_bf16 v[40:43], a[40:43], v[120:123], v[40:43]
    v_mfma_f32_16x16x32_bf16 v[44:47], a[44:47], v[120:123], v[44:47]
    v_mfma_f32_16x16x32_bf16 v[48:51], a[32:35], v[124:127], v[48:51]
    v_mfma_f32_16x16x32_bf16 v[52:55], a[36:39], v[124:127], v[52:55]
    v_mfma_f32_16x16x32_bf16 v[56:59], a[40:43], v[124:127], v[56:59]
    v_mfma_f32_16x16x32_bf16 v[60:63], a[44:47], v[124:127], v[60:63]
    s_lshl_b32 s68, s67, 2
    v_mov_b32 v150, s68
    s_mov_b32 s69, 262144
L_LW_13:
    ds_read_b32 v151, v150 offset:1568
    s_sub_u32 s69, s69, 1
    s_cbranch_scc1 L_LWX_14
    s_waitcnt lgkmcnt(0)
    v_cmp_ne_u32 vcc, 1, v151
    s_cbranch_vccnz L_LW_13
L_LWX_14:
    s_waitcnt vmcnt(8)
    s_cmp_eq_u32 s75, 6
    s_cbranch_scc1 L_SWP6
L_SWPX6:
    v_mfma_f32_16x16x32_bf16 v[0:3], a[48:51], v[64:67], v[0:3]
    v_mfma_f32_16x16x32_bf16 v[4:7], a[52:55], v[64:67], v[4:7]
    v_mfma_f32_16x16x32_bf16 v[8:11], a[56:59], v[64:67], v[8:11]
    v_mfma_f32_16x16x32_bf16 v[12:15], a[60:63], v[64:67], v[12:15]
    v_mfma_f32_16x16x32_bf16 v[16:19], a[48:51], v[68:71], v[16:19]
    v_mfma_f32_16x16x32_bf16 v[20:23], a[52:55], v[68:71], v[20:23]
    v_mfma_f32_16x16x32_bf16 v[24:27], a[56:59], v[68:71], v[24:27]
    v_mfma_f32_16x16x32_bf16 v[28:31], a[60:63], v[68:71], v[28:31]
    v_mfma_f32_16x16x32_bf16 v[32:35], a[48:51], v[72:75], v[32:35]
    v_mfma_f32_16x16x32_bf16 v[36:39], a[52:55], v[72:75], v[36:39]
    v_mfma_f32_16x16x32_bf16 v[40:43], a[56:59], v[72:75], v[40:43]
    v_mfma_f32_16x16x32_bf16 v[44:47], a[60:63], v[72:75], v[44:47]
    v_mfma_f32_16x16x32_bf16 v[48:51], a[48:51], v[76:79], v[48:51]
    v_mfma_f32_16x16x32_bf16 v[52:55], a[52:55], v[76:79], v[52:55]
    v_mfma_f32_16x16x32_bf16 v[56:59], a[56:59], v[76:79], v[56:59]
    v_mfma_f32_16x16x32_bf16 v[60:63], a[60:63], v[76:79], v[60:63]
    s_waitcnt vmcnt(4)
    s_cmp_eq_u32 s75, 5
    s_cbranch_scc1 L_SWP7
L_SWPX7:
    v_mfma_f32_16x16x32_bf16 v[0:3], a[64:67], v[128:131], v[0:3]
    v_mfma_f32_16x16x32_bf16 v[4:7], a[68:71], v[128:131], v[4:7]
    v_mfma_f32_16x16x32_bf16 v[8:11], a[72:75], v[128:131], v[8:11]
    v_mfma_f32_16x16x32_bf16 v[12:15], a[76:79], v[128:131], v[12:15]
    v_mfma_f32_16x16x32_bf16 v[16:19], a[64:67], v[132:135], v[16:19]
    v_mfma_f32_16x16x32_bf16 v[20:23], a[68:71], v[132:135], v[20:23]
    v_mfma_f32_16x16x32_bf16 v[24:27], a[72:75], v[132:135], v[24:27]
    v_mfma_f32_16x16x32_bf16 v[28:31], a[76:79], v[132:135], v[28:31]
    v_mfma_f32_16x16x32_bf16 v[32:35], a[64:67], v[136:139], v[32:35]
    v_mfma_f32_16x16x32_bf16 v[36:39], a[68:71], v[136:139], v[36:39]
    v_mfma_f32_16x16x32_bf16 v[40:43], a[72:75], v[136:139], v[40:43]
    v_mfma_f32_16x16x32_bf16 v[44:47], a[76:79], v[136:139], v[44:47]
    v_mfma_f32_16x16x32_bf16 v[48:51], a[64:67], v[140:143], v[48:51]
    v_mfma_f32_16x16x32_bf16 v[52:55], a[68:71], v[140:143], v[52:55]
    v_mfma_f32_16x16x32_bf16 v[56:59], a[72:75], v[140:143], v[56:59]
    v_mfma_f32_16x16x32_bf16 v[60:63], a[76:79], v[140:143], v[60:63]
    s_waitcnt vmcnt(0)
    s_cmp_eq_u32 s75, 4
    s_cbranch_scc1 L_SWP8
L_SWPX8:
    v_mfma_f32_16x16x32_bf16 v[0:3], a[80:83], v[96:99], v[0:3]
    v_mfma_f32_16x16x32_bf16 v[4:7], a[84:87], v[96:99], v[4:7]
    v_mfma_f32_16x16x32_bf16 v[8:11], a[88:91], v[96:99], v[8:11]
    v_mfma_f32_16x16x32_bf16 v[12:15], a[92:95], v[96:99], v[12:15]
    v_mfma_f32_16x16x32_bf16 v[16:19], a[80:83], v[100:103], v[16:19]
    v_mfma_f32_16x16x32_bf16 v[20:23], a[84:87], v[100:103], v[20:23]
    v_mfma_f32_16x16x32_bf16 v[24:27], a[88:91], v[100:103], v[24:27]
    v_mfma_f32_16x16x32_bf16 v[28:31], a[92:95], v[100:103], v[28:31]
    v_mfma_f32_16x16x32_bf16 v[32:35], a[80:83], v[104:107], v[32:35]
    v_mfma_f32_16x16x32_bf16 v[36:39], a[84:87], v[104:107], v[36:39]
    v_mfma_f32_16x16x32_bf16 v[40:43], a[88:91], v[104:107], v[40:43]
    v_mfma_f32_16x16x32_bf16 v[44:47], a[92:95], v[104:107], v[44:47]
    v_mfma_f32_16x16x32_bf16 v[48:51], a[80:83], v[108:111], v[48:51]
    v_mfma_f32_16x16x32_bf16 v[52:55], a[84:87], v[108:111], v[52:55]
    v_mfma_f32_16x16x32_bf16 v[56:59], a[88:91], v[108:111], v[56:59]
    v_mfma_f32_16x16x32_bf16 v[60:63], a[92:95], v[108:111], v[60:63]
    v_lshrrev_b32 v150, 3, v144
    s_and_b32 s68, s60, 1
    s_lshl_b32 s68, s68, 3
    v_add_u32 v150, s68, v150
    v_and_b32 v151, 7, v144
    v_lshlrev_b32 v157, 1, v151
    v_xor_b32 v157, v157, v150
    v_lshlrev_b32 v157, 4, v157
    v_lshl_add_u32 v157, v151, 9, v157
    s_lshr_b32 s69, s60, 1
    s_lshl_b32 s70, s69, 14
    s_add_u32 s70, s70, 4096
    v_add_u32 v157, s70, v157
    v_add_u32 v158, 0x10000, v157
    ds_write_b128 v145, v[0:3] offset:0
    ds_write_b128 v146, v[4:7] offset:0
    ds_write_b128 v147, v[8:11] offset:0
    ds_write_b128 v148, v[12:15] offset:0
    ds_write_b128 v145, v[16:19] offset:16384
    ds_write_b128 v146, v[20:23] offset:16384
    ds_write_b128 v147, v[24:27] offset:16384
    ds_write_b128 v148, v[28:31] offset:16384
    ds_write_b128 v145, v[32:35] offset:32768
    ds_write_b128 v146, v[36:39] offset:32768
    ds_write_b128 v147, v[40:43] offset:32768
    ds_write_b128 v148, v[44:47] offset:32768
    ds_write_b128 v145, v[48:51] offset:49152
    ds_write_b128 v146, v[52:55] offset:49152
    ds_write_b128 v147, v[56:59] offset:49152
    ds_write_b128 v148, v[60:63] offset:49152
    s_lshr_b32 s70, s69, 1
    s_lshl_b32 s70, s70, 5
    s_and_b32 s69, s69, 1
    s_add_u32 s70, s70, s69
    s_lshl_b32 s69, s65, 6
    s_add_u32 s70, s70, s69
    v_lshl_add_u32 v150, v150, 1, s70
    v_lshlrev_b32 v150, 10, v150
    v_lshl_add_u32 v150, v151, 4, v150
    s_lshl_b32 s70, s66, 7
    v_mul_f32 v156, 0x3fb8aa3b, v156
    v_exp_f32 v156, v156
    s_nop 0
    v_add_f32 v156, 1.0, v156
    v_rcp_f32 v156, v156
    v_lshlrev_b32 v64, 16, v152
    v_and_b32 v65, 0xffff0000, v152
    v_lshlrev_b32 v66, 16, v153
    v_and_b32 v67, 0xffff0000, v153
    v_lshlrev_b32 v68, 16, v154
    v_and_b32 v69, 0xffff0000, v154
    v_lshlrev_b32 v70, 16, v155
    v_and_b32 v71, 0xffff0000, v155
    v_mul_f32 v64, v156, v64
    v_mul_f32 v65, v156, v65
    v_mul_f32 v66, v156, v66
    v_mul_f32 v67, v156, v67
    v_mul_f32 v68, v156, v68
    v_mul_f32 v69, v156, v69
    v_mul_f32 v70, v156, v70
    v_mul_f32 v71, v156, v71
    s_waitcnt lgkmcnt(0)
    s_barrier
    ds_read_b128 v[0:3], v157 offset:0
    ds_read_b128 v[4:7], v157 offset:256
    ds_read_b128 v[8:11], v157 offset:4096
    ds_read_b128 v[12:15], v157 offset:4352
    ds_read_b128 v[16:19], v157 offset:8192
    ds_read_b128 v[20:23], v157 offset:8448
    ds_read_b128 v[24:27], v157 offset:12288
    ds_read_b128 v[28:31], v157 offset:12544
    ds_read_b128 v[32:35], v158 offset:0
    ds_read_b128 v[36:39], v158 offset:256
    ds_read_b128 v[40:43], v158 offset:4096
    ds_read_b128 v[44:47], v158 offset:4352
    ds_read_b128 v[48:51], v158 offset:8192
    ds_read_b128 v[52:55], v158 offset:8448
    ds_read_b128 v[56:59], v158 offset:12288
    ds_read_b128 v[60:63], v158 offset:12544
    s_waitcnt lgkmcnt(14)
    v_pk_add_f32 v[64:65], v[64:65], v[0:1]
    v_pk_add_f32 v[66:67], v[66:67], v[2:3]
    v_pk_add_f32 v[68:69], v[68:69], v[4:5]
    v_pk_add_f32 v[70:71], v[70:71], v[6:7]
    s_waitcnt lgkmcnt(12)
    v_pk_add_f32 v[64:65], v[64:65], v[8:9]
    v_pk_add_f32 v[66:67], v[66:67], v[10:11]
    v_pk_add_f32 v[68:69], v[68:69], v[12:13]
    v_pk_add_f32 v[70:71], v[70:71], v[14:15]
    s_waitcnt lgkmcnt(10)
    v_pk_add_f32 v[64:65], v[64:65], v[16:17]
    v_pk_add_f32 v[66:67], v[66:67], v[18:19]
    v_pk_add_f32 v[68:69], v[68:69], v[20:21]
    v_pk_add_f32 v[70:71], v[70:71], v[22:23]
    s_waitcnt lgkmcnt(8)
    v_pk_add_f32 v[64:65], v[64:65], v[24:25]
    v_pk_add_f32 v[66:67], v[66:67], v[26:27]
    v_pk_add_f32 v[68:69], v[68:69], v[28:29]
    v_pk_add_f32 v[70:71], v[70:71], v[30:31]
    s_waitcnt lgkmcnt(6)
    v_pk_add_f32 v[64:65], v[64:65], v[32:33]
    v_pk_add_f32 v[66:67], v[66:67], v[34:35]
    v_pk_add_f32 v[68:69], v[68:69], v[36:37]
    v_pk_add_f32 v[70:71], v[70:71], v[38:39]
    s_waitcnt lgkmcnt(4)
    v_pk_add_f32 v[64:65], v[64:65], v[40:41]
    v_pk_add_f32 v[66:67], v[66:67], v[42:43]
    v_pk_add_f32 v[68:69], v[68:69], v[44:45]
    v_pk_add_f32 v[70:71], v[70:71], v[46:47]
    s_waitcnt lgkmcnt(2)
    v_pk_add_f32 v[64:65], v[64:65], v[48:49]
    v_pk_add_f32 v[66:67], v[66:67], v[50:51]
    v_pk_add_f32 v[68:69], v[68:69], v[52:53]
    v_pk_add_f32 v[70:71], v[70:71], v[54:55]
    s_waitcnt lgkmcnt(0)
    v_pk_add_f32 v[64:65], v[64:65], v[56:57]
    v_pk_add_f32 v[66:67], v[66:67], v[58:59]
    v_pk_add_f32 v[68:69], v[68:69], v[60:61]
    v_pk_add_f32 v[70:71], v[70:71], v[62:63]
    v_cvt_pk_bf16_f32 v72, v64, v65
    v_cvt_pk_bf16_f32 v73, v66, v67
    v_cvt_pk_bf16_f32 v74, v68, v69
    v_cvt_pk_bf16_f32 v75, v70, v71
    buffer_store_dwordx4 v[72:75], v150, s[48:51], s70 offen
L_END:
    s_endpgm
L_EPUB1:
    s_mov_b32 s68, 9486336
    s_mov_b64 exec, 1
    buffer_store_dword v23, off, s[52:55], 0 sc1
    s_mov_b64 exec, -1
    s_branch L_EPUBX1
L_EPUB3:
    s_mov_b32 s68, 9486336
    s_mov_b64 exec, 1
    buffer_store_dword v23, off, s[44:47], s68 sc1
    s_mov_b64 exec, -1
    s_branch L_EPUBX3
L_ZPOLL:
    buffer_load_dwordx2 v[14:15], v24, s[44:47], s82 offen sc1
    s_sub_u32 s69, s69, 1
    s_cbranch_scc1 L_ZGOT
    s_waitcnt vmcnt(0)
    v_cmp_ne_u32 vcc, s11, v15
    s_cbranch_vccnz L_ZPOLL
    s_branch L_ZGOT
L_FLOOP_SIG:
    ds_write_b32 v134, v135 offset:1552
    v_add_u32 v134, 32, v134
    s_branch L_FLOOP_BACK
L_ALOOP_SIG:
    ds_write_b32 v134, v135 offset:1552
    v_add_u32 v134, 32, v134
    s_branch L_ALOOP_BACK
L_CPUB0:
    s_waitcnt vmcnt(0)
    s_branch L_CPUBX
L_PL_7:
    buffer_load_dword v157, v159, s[44:47], s82 offen sc1
    s_sub_u32 s69, s69, 1
    s_cbranch_scc1 L_PLX_8
    s_waitcnt vmcnt(0)
    s_branch L_PLC_9
L_PL_10:
    buffer_load_dword v157, v159, s[44:47], s82 offen sc1
    s_sub_u32 s69, s69, 1
    s_cbranch_scc1 L_PLX_11
    s_waitcnt vmcnt(0)
    s_branch L_PLC_12
L_SWP2:
    v_swap_b32 v66, v68
    v_swap_b32 v67, v69
    v_swap_b32 v74, v76
    v_swap_b32 v75, v77
    s_nop 1
    s_branch L_SWPX2
L_SWP3:
    v_swap_b32 v98, v100
    v_swap_b32 v99, v101
    v_swap_b32 v106, v108
    v_swap_b32 v107, v109
    s_nop 1
    s_branch L_SWPX3
L_SWP4:
    v_swap_b32 v82, v84
    v_swap_b32 v83, v85
    v_swap_b32 v90, v92
    v_swap_b32 v91, v93
    s_nop 1
    s_branch L_SWPX4
L_SWP5:
    v_swap_b32 v114, v116
    v_swap_b32 v115, v117
    v_swap_b32 v122, v124
    v_swap_b32 v123, v125
    s_nop 1
    s_branch L_SWPX5
L_SWP6:
    v_swap_b32 v66, v68
    v_swap_b32 v67, v69
    v_swap_b32 v74, v76
    v_swap_b32 v75, v77
    s_nop 1
    s_branch L_SWPX6
L_SWP7:
    v_swap_b32 v130, v132
    v_swap_b32 v131, v133
    v_swap_b32 v138, v140
    v_swap_b32 v139, v141
    s_nop 1
    s_branch L_SWPX7
L_SWP8:
    v_swap_b32 v98, v100
    v_swap_b32 v99, v101
    v_swap_b32 v106, v108
    v_swap_b32 v107, v109
    s_nop 1
    s_branch L_SWPX8
.section .rodata,"a"
.p2align 6
.amdhsa_kernel gated_mix__sliding_local_dilated__dense_activation_gelu__prompt_kernel
  .amdhsa_next_free_vgpr 256
  .amdhsa_next_free_sgpr 102
  .amdhsa_accum_offset 160
  .amdhsa_group_segment_fixed_size 0
  .amdhsa_kernarg_size 96
  .amdhsa_user_sgpr_count 2
  .amdhsa_user_sgpr_kernarg_segment_ptr 1
  .amdhsa_system_sgpr_workgroup_id_x 1
.end_amdhsa_kernel
```
